```python
import torch

def _softmax(x, axis=-1):
    return torch.softmax(x, dim=axis)
def _gelu(x):
    return torch.nn.functional.gelu(x, approximate="tanh")
def _silu(x):
    return torch.nn.functional.silu(x)
def _sigmoid(x):
    return torch.sigmoid(x)
def _layernorm(x, axis=-1, eps=1e-5):
    m = x.mean(dim=axis, keepdim=True)
    v = x.var(dim=axis, keepdim=True, unbiased=False)
    return (x - m) / torch.sqrt(v + eps)
def _scatter_add(tgt, idx, src, axis=0):
    return tgt.clone().index_add_(axis, idx, src)
def _segment_sum(src, seg, n):
    out = torch.zeros((n,) + src.shape[1:], dtype=src.dtype)
    return out.index_add_(0, seg, src)
def _pad(x, pw):
    flat = tuple(v for pair in reversed(pw) for v in pair)
    return torch.nn.functional.pad(x, flat)

kernel_name = 'concat_heads__mha_block_cached__gqa_block_cached__near_ridge'

def setup_inputs():

    _w = (lambda a: (lambda t: t.to(torch.bfloat16) if t.is_floating_point() else t)(torch.as_tensor(a)))
    def _A_setup():
        B, Sq, D = 8, 144, 576
        H, Sk, Dh = 32, 512, 128
        return {
            "x": _w((lambda *s: torch.randn(*s, dtype=torch.bfloat16) * 0.8)(B, Sq, D)),
            "k_cache": _w((lambda *s: torch.randn(*s, dtype=torch.bfloat16) * 0.8)(B, H, Sk, Dh)),
            "v_cache": _w((lambda *s: torch.randn(*s, dtype=torch.bfloat16) * 0.05)(B, H, Sk, Dh)),
            "wq": _w((lambda *s: torch.randn(*s, dtype=torch.bfloat16) * 0.8)(D, H * Dh) * (D ** -0.5)),
            "wo": _w((lambda *s: torch.randn(*s, dtype=torch.bfloat16) * 0.05)(H * Dh, D) * ((H * Dh) ** -0.5)),
        }
    _A_in = _A_setup()

    def _B_setup():
        B, Sq, D = 8, 144, 576
        Hq, Hkv, Sk, Dh = 32, 32, 512, 128
        assert Hq % Hkv == 0, (Hq, Hkv)
        return {
            "x": _w((lambda *s: torch.randn(*s, dtype=torch.bfloat16) * 0.8)(B, Sq, D)),
            "k_cache": _w((lambda *s: torch.randn(*s, dtype=torch.bfloat16) * 0.8)(B, Hkv, Sk, Dh)),
            "v_cache": _w((lambda *s: torch.randn(*s, dtype=torch.bfloat16) * 0.05)(B, Hkv, Sk, Dh)),
            "wq": _w((lambda *s: torch.randn(*s, dtype=torch.bfloat16) * 0.8)(D, Hq * Dh) * (D ** -0.5)),
            "wo": _w((lambda *s: torch.randn(*s, dtype=torch.bfloat16) * 0.05)(Hq * Dh, D) * ((Hq * Dh) ** -0.5)),
        }
    _B_in = _B_setup()

    return {
        "A_x": _A_in["x"],
        "A_k_cache": _A_in["k_cache"],
        "A_v_cache": _A_in["v_cache"],
        "A_wq": _A_in["wq"],
        "A_wo": _A_in["wo"],
        "B_x": _B_in["x"],
        "B_k_cache": _B_in["k_cache"],
        "B_v_cache": _B_in["v_cache"],
        "B_wq": _B_in["wq"],
        "B_wo": _B_in["wo"],
    }

def reference(A_x, A_k_cache, A_v_cache, A_wq, A_wo, B_x, B_k_cache, B_v_cache, B_wq, B_wo):
    def _A_ref(x, k_cache, v_cache, wq, wo):
        B, Sq, D = x.shape
        H, Dh = 32, 128
        q = (lambda x, *d: x.permute(*d))((x @ wq).reshape(B, Sq, H, Dh), 0, 2, 1, 3)
        scores = torch.einsum("bhqd,bhkd->bhqk", q, k_cache) * (Dh ** -0.5)
        p = _softmax(scores, axis=-1)
        o = torch.einsum("bhqk,bhkd->bhqd", p, v_cache)
        return (lambda x, *d: x.permute(*d))(o, 0, 2, 1, 3).reshape(B, Sq, H * Dh) @ wo

    def _B_ref(x, k_cache, v_cache, wq, wo):
        B, Sq, D = x.shape
        Hq, Dh = 32, 128
        Hkv = k_cache.shape[1]
        rep = Hq // Hkv
        q = (lambda x, *d: x.permute(*d))((x @ wq).reshape(B, Sq, Hq, Dh), 0, 2, 1, 3)
        k = (lambda x, n, axis: torch.repeat_interleave(x, n, dim=axis))(k_cache, rep, axis=1)
        v = (lambda x, n, axis: torch.repeat_interleave(x, n, dim=axis))(v_cache, rep, axis=1)
        scores = torch.einsum("bhqd,bhkd->bhqk", q, k) * (Dh ** -0.5)
        p = _softmax(scores, axis=-1)
        o = torch.einsum("bhqk,bhkd->bhqd", p, v)
        return (lambda x, *d: x.permute(*d))(o, 0, 2, 1, 3).reshape(B, Sq, Hq * Dh) @ wo

    a = _A_ref(A_x, A_k_cache, A_v_cache, A_wq, A_wo)
    b = _B_ref(B_x, B_k_cache, B_v_cache, B_wq, B_wo)
    return torch.concatenate([a, b], axis=-1)
```

```asm
; @launch grid=(256,1,1) block=(512,1,1) lds=163840
.amdgcn_target "amdgcn-amd-amdhsa--gfx950"
.text
.globl concat_heads__mha_block_cached__gqa_block_cached__near_ridge_kernel
.p2align 8
.type concat_heads__mha_block_cached__gqa_block_cached__near_ridge_kernel,@function
concat_heads__mha_block_cached__gqa_block_cached__near_ridge_kernel:
K1_START:
    s_cmp_ge_u32 s2, 256
    s_cbranch_scc1 K1_END
    s_bfe_u32 s29, s2, 0x10002
    s_mul_i32 s6, s29, 40
    s_add_u32 s4, s0, s6
    s_addc_u32 s5, s1, 0
    s_load_dwordx8 s[56:63], s[4:5], 0
    s_load_dwordx4 s[64:67], s[0:1], 88
    s_load_dwordx2 s[68:69], s[0:1], 80
    s_load_dwordx2 s[100:101], s[4:5], 32
    v_lshrrev_b32 v1, 6, v0
    v_and_b32 v225, 63, v0
    v_readfirstlane_b32 s24, v1
    v_lshrrev_b32 v2, 4, v225
    v_and_b32 v3, 15, v225
    s_and_b32 s3, s2, 3
    s_lshl_b32 s3, s3, 2
    s_bfe_u32 s7, s2, 0x20003
    s_add_u32 s28, s3, s7
    s_lshr_b32 s27, s2, 5
    s_and_b32 s25, s24, 3
    s_lshr_b32 s26, s24, 2
    v_lshlrev_b32 v4, 2, v2
    v_xor_b32 v4, v4, v3
    v_lshlrev_b32 v4, 4, v4
    v_lshl_add_u32 v218, v2, 13, v4
    v_lshrrev_b32 v8, 2, v225
    v_and_b32 v9, 3, v225
    v_xor_b32 v9, v9, v2
    v_mul_u32_u24 v8, 1152, v8
    v_lshl_add_u32 v219, v9, 4, v8
    s_lshl_b32 s3, s25, 2
    v_or_b32 v5, s3, v2
    v_xor_b32 v5, v5, v3
    v_lshlrev_b32 v5, 4, v5
    s_lshl_b32 s50, s25, 12
    v_lshl_add_u32 v5, v2, 8, v5
    v_add_u32 v220, s50, v5
    v_lshl_add_u32 v5, v2, 8, v4
    v_add_u32 v221, s50, v5
    s_lshl_b32 s31, s25, 16
    s_mul_i32 s33, s25, 18432
    s_mul_i32 s35, s25, 3072
    s_lshl_b32 s3, s25, 4
    s_lshl_b64 s[38:39], 0xffff, s3
    s_mul_i32 s6, s27, 165888
    s_lshl_b32 s7, s28, 9
    s_mov_b32 s11, 0x20000
    s_mov_b32 s22, 167936
    s_mov_b32 s23, 0x20000
    s_sub_u32 s10, 4718592, s7
    s_mov_b32 s36, 35840
    s_lshl_b32 s48, s27, 5
    s_lshl_b32 s49, s28, 1
    s_add_u32 s48, s48, s49
    s_lshl_b32 s48, s48, 17
    s_mov_b32 s14, 262144
    s_mov_b32 s15, 0x20000
    s_mov_b32 s18, 262144
    s_mov_b32 s19, 0x20000
    s_mov_b32 s30, 0
    s_cmp_ge_u32 s24, 4
    s_waitcnt lgkmcnt(0)
    s_cbranch_scc1 K1_G1
    s_add_u32 s8, s62, s7
    s_addc_u32 s9, s63, 0
    s_add_u32 s20, s56, s6
    s_addc_u32 s21, s57, 0
    s_sub_u32 s20, s20, 2048
    s_subb_u32 s21, s21, 0
    s_and_b32 s3, s28, 3
    s_lshl_b32 s47, 1, s3
    s_add_u32 s52, s66, 50331648
    s_addc_u32 s53, s67, 0
    s_mov_b32 s54, 32768
    s_mov_b32 s55, 0x20000
    s_lshl_b32 s3, s29, 3
    s_add_u32 s3, s3, s27
    s_lshl_b32 s6, s3, 2
    v_mov_b32 v146, s6
    s_lshl_b32 s6, s29, 5
    s_add_u32 s6, s6, s27
    s_lshl_b32 s6, s6, 7
    v_mov_b32 v147, s6
    v_mov_b32 v144, 0
    s_and_b32 s3, s2, 0x1b
    s_or_b32 s3, s3, s24
    s_cbranch_scc1 K1_EPL
    s_mov_b64 exec, 1
    buffer_load_dword v144, v147, s[52:55], 0 offen sc1
    s_mov_b64 exec, -1
K1_EPL:
    s_add_u32 m0, s35, 87040
    s_add_u32 s3, s31, 0
    buffer_load_dwordx4 v218, s[8:11], s3 offen  lds
    s_add_u32 s3, s3, 31744
    buffer_load_dwordx4 v218, s[8:11], s3 offen offset:1024  lds
    s_add_u32 s3, s33, 0
    buffer_load_dwordx4 v219, s[20:23], s3 offen offset:2048  lds
    s_add_u32 m0, s35, 99328
    s_add_u32 s3, s31, 256
    buffer_load_dwordx4 v218, s[8:11], s3 offen  lds
    s_add_u32 s3, s3, 31744
    buffer_load_dwordx4 v218, s[8:11], s3 offen offset:1024  lds
    s_add_u32 s3, s33, 73728
    buffer_load_dwordx4 v219, s[20:23], s3 offen offset:2048  lds
    s_mov_b32 m0, 111616
    s_mov_b32 s3, 149504
    s_mov_b64 exec, s[38:39]
    buffer_load_dwordx4 v219, s[20:23], s3 offen  lds
    s_mov_b64 exec, -1
    v_lshrrev_b32 v232, 2, v225
    v_and_b32 v233, 3, v225
    v_lshlrev_b32 v233, 7, v233
    v_lshl_add_u32 v232, v232, 13, v233
    v_mul_u32_u24 v235, 16384, v225
    v_lshrrev_b32 v235, 16, v235
    v_mul_u32_u24 v233, 640, v235
    v_lshl_add_u32 v233, v225, 7, v233
    s_lshl_b32 s3, s27, 2
    s_add_u32 s3, s3, s25
    s_mul_i32 s3, s3, 57344
    s_add_u32 s3, s3, 262144
    s_and_b32 s6, s28, 3
    s_lshl_b32 s6, s6, 2
    s_add_u32 s6, s6, s25
    s_mul_i32 s6, s6, 10368
    s_add_u32 s6, s6, 2048
    s_mov_b64 exec, 0xfffffff
    buffer_load_dword v234, v232, s[8:11], s3 offen
    s_mov_b32 exec_lo, -1
    s_mov_b32 exec_hi, 0xf
    buffer_load_dword v234, v233, s[20:23], s6 offen
    s_mov_b64 exec, -1
    v_lshrrev_b32 v232, 2, v225
    v_and_b32 v233, 3, v225
    v_lshlrev_b32 v233, 7, v233
    v_lshl_add_u32 v232, v232, 13, v233
    v_mul_u32_u24 v235, 13108, v225
    v_lshrrev_b32 v235, 16, v235
    v_mul_u32_u24 v233, 512, v235
    v_lshl_add_u32 v233, v225, 7, v233
    s_lshl_b32 s3, s27, 2
    s_add_u32 s3, s3, s25
    s_mul_i32 s3, s3, 81920
    s_add_u32 s3, s3, 2097152
    s_and_b32 s6, s28, 3
    s_lshl_b32 s6, s6, 2
    s_add_u32 s6, s6, s25
    s_mul_i32 s6, s6, 10368
    s_add_u32 s6, s6, 2560
    s_mov_b32 exec_lo, -1
    s_mov_b32 exec_hi, 0xff
    buffer_load_dword v234, v232, s[8:11], s3 offen
    s_mov_b32 exec_lo, -1
    s_mov_b32 exec_hi, 0x1fff
    buffer_load_dword v234, v233, s[20:23], s6 offen
    s_mov_b64 exec, -1
    s_add_u32 s12, s58, s48
    s_addc_u32 s13, s59, 0
    s_add_u32 s16, s60, s48
    s_addc_u32 s17, s61, 0
    s_lshr_b32 s49, s2, 3
    s_mul_i32 s3, s2, 0
    s_mul_i32 s49, s49, 1
    s_add_u32 s49, s49, s3
    s_lshl_b32 s49, s49, 14
    s_add_u32 s52, s66, 50331648
    s_addc_u32 s53, s67, 0
    s_mov_b32 s54, 32768
    s_mov_b32 s55, 0x20000
    s_mov_b32 s56, s64
    s_mov_b32 s57, s65
    s_mov_b32 s58, 256
    s_mov_b32 s59, 0x20000
    s_waitcnt vmcnt(4)
    s_barrier
    s_and_b32 s3, s2, 0x1b
    s_or_b32 s3, s3, s24
    s_cbranch_scc1 K1_EP0
    s_mov_b32 s3, 1664525
    s_waitcnt vmcnt(11)
    v_mul_lo_u32 v144, s3, v144
    v_add_u32 v144, 1013904223, v144
    v_max_u32 v144, 1, v144
    s_mov_b64 exec, 1
    buffer_store_dword v144, v146, s[56:59], 0 offen sc1
    s_mov_b64 exec, -1
K1_EP0:
    s_add_u32 m0, s35, 112640
    s_add_u32 s3, s31, 262144
    buffer_load_dwordx4 v218, s[8:11], s3 offen  lds
    s_add_u32 s3, s3, 31744
    buffer_load_dwordx4 v218, s[8:11], s3 offen offset:1024  lds
    s_add_u32 s3, s33, 64
    buffer_load_dwordx4 v219, s[20:23], s3 offen offset:2048  lds
    s_add_u32 m0, s35, 124928
    s_add_u32 s3, s31, 262400
    buffer_load_dwordx4 v218, s[8:11], s3 offen  lds
    s_add_u32 s3, s3, 31744
    buffer_load_dwordx4 v218, s[8:11], s3 offen offset:1024  lds
    s_add_u32 s3, s33, 73792
    buffer_load_dwordx4 v219, s[20:23], s3 offen offset:2048  lds
    s_mov_b32 m0, 137216
    s_mov_b32 s3, 149568
    s_mov_b64 exec, s[38:39]
    buffer_load_dwordx4 v219, s[20:23], s3 offen  lds
    s_mov_b64 exec, -1
    v_lshlrev_b32 v230, 4, v225
    v_add_u32 v230, s50, v230
    v_add_u32 v231, 0x10000, v230
    s_waitcnt vmcnt(0)
    s_barrier
    s_add_u32 m0, s35, 138240
    s_add_u32 s3, s31, 524288
    buffer_load_dwordx4 v218, s[8:11], s3 offen  lds
    s_add_u32 s3, s3, 31744
    buffer_load_dwordx4 v218, s[8:11], s3 offen offset:1024  lds
    s_add_u32 s3, s33, 128
    buffer_load_dwordx4 v219, s[20:23], s3 offen offset:2048  lds
    s_add_u32 m0, s35, 150528
    s_add_u32 s3, s31, 524544
    buffer_load_dwordx4 v218, s[8:11], s3 offen  lds
    s_add_u32 s3, s3, 31744
    buffer_load_dwordx4 v218, s[8:11], s3 offen offset:1024  lds
    s_add_u32 s3, s33, 73856
    buffer_load_dwordx4 v219, s[20:23], s3 offen offset:2048  lds
    s_mov_b32 m0, 162816
    s_mov_b32 s3, 149632
    s_mov_b64 exec, s[38:39]
    buffer_load_dwordx4 v219, s[20:23], s3 offen  lds
    s_mov_b64 exec, -1
    s_add_u32 m0, s35, 35840
    s_add_u32 s3, s31, 786432
    buffer_load_dwordx4 v218, s[8:11], s3 offen  lds
    s_add_u32 s3, s3, 31744
    buffer_load_dwordx4 v218, s[8:11], s3 offen offset:1024  lds
    s_add_u32 s3, s33, 192
    buffer_load_dwordx4 v219, s[20:23], s3 offen offset:2048  lds
    s_add_u32 m0, s35, 48128
    s_add_u32 s3, s31, 786688
    buffer_load_dwordx4 v218, s[8:11], s3 offen  lds
    s_add_u32 s3, s3, 31744
    buffer_load_dwordx4 v218, s[8:11], s3 offen offset:1024  lds
    s_add_u32 s3, s33, 73920
    buffer_load_dwordx4 v219, s[20:23], s3 offen offset:2048  lds
    s_mov_b32 m0, 60416
    s_mov_b32 s3, 149696
    s_mov_b64 exec, s[38:39]
    buffer_load_dwordx4 v219, s[20:23], s3 offen  lds
    s_mov_b64 exec, -1
    v_bfe_u32 v10, v225, 2, 2
    v_and_b32 v11, 3, v225
    v_lshrrev_b32 v12, 5, v225
    v_and_b32 v13, 1, v2
    v_and_b32 v20, 1, v11
    v_lshrrev_b32 v15, 1, v11
    v_lshlrev_b32 v16, 2, v10
    v_lshl_add_u32 v17, v13, 1, v20
    v_xor_b32 v17, v17, v16
    v_lshlrev_b32 v17, 4, v17
    v_lshl_add_u32 v17, v15, 3, v17
    v_lshl_add_u32 v17, v10, 8, v17
    s_lshl_b32 s3, s26, 14
    s_add_u32 s50, s50, s3
    s_add_u32 s6, s3, 65536
    v_lshl_add_u32 v18, v12, 10, v17
    v_add_u32 v226, s6, v18
    v_xor_b32 v227, 64, v226
    v_xor_b32 v228, 0x80, v226
    v_xor_b32 v229, 0xc0, v226
    v_bfe_u32 v23, v225, 3, 2
    v_bfe_u32 v24, v225, 2, 1
    v_lshl_add_u32 v25, v23, 2, v11
    v_xor_b32 v25, v25, v12
    v_lshlrev_b32 v25, 4, v25
    v_lshl_add_u32 v25, v11, 8, v25
    v_lshl_add_u32 v25, v24, 10, v25
    v_lshl_add_u32 v25, v23, 12, v25
    v_add_u32 v222, s3, v25
    s_lshl_b32 s7, s25, 10
    s_add_u32 s6, s3, s7
    v_xor_b32 v25, v2, v3
    v_lshlrev_b32 v25, 4, v25
    v_lshl_add_u32 v25, v11, 8, v25
    v_lshl_add_u32 v25, v10, 12, v25
    v_add_u32 v223, s6, v25
    v_xor_b32 v25, v15, v16
    v_lshlrev_b32 v25, 4, v25
    v_lshl_add_u32 v25, v20, 3, v25
    v_lshl_add_u32 v25, v10, 8, v25
    v_lshl_add_u32 v25, v2, 12, v25
    s_add_u32 s6, s6, 65536
    s_lshl_b32 s7, s25, 6
    v_xor_b32 v25, s7, v25
    v_add_u32 v224, s6, v25
    v_mul_u32_u24 v26, 272, v3
    v_lshl_add_u32 v27, v2, 4, v26
    s_mul_i32 s6, s26, 4352
    s_add_u32 s6, s6, 114688
    v_add_u32 v208, s6, v27
    v_lshlrev_b32 v27, 4, v225
    s_lshl_b32 s6, s25, 13
    s_add_u32 s6, s6, 131072
    v_add_u32 v209, s6, v27
    s_waitcnt vmcnt(7)
    s_barrier
    s_add_u32 m0, s35, 61440
    s_add_u32 s3, s31, 1048576
    buffer_load_dwordx4 v218, s[8:11], s3 offen  lds
    s_add_u32 s3, s3, 31744
    buffer_load_dwordx4 v218, s[8:11], s3 offen offset:1024  lds
    s_add_u32 s3, s33, 256
    buffer_load_dwordx4 v219, s[20:23], s3 offen offset:2048  lds
    s_add_u32 m0, s35, 73728
    s_add_u32 s3, s31, 1048832
    buffer_load_dwordx4 v218, s[8:11], s3 offen  lds
    s_add_u32 s3, s3, 31744
    buffer_load_dwordx4 v218, s[8:11], s3 offen offset:1024  lds
    s_add_u32 s3, s33, 73984
    buffer_load_dwordx4 v219, s[20:23], s3 offen offset:2048  lds
    s_mov_b32 m0, 86016
    s_mov_b32 s3, 149760
    s_mov_b64 exec, s[38:39]
    buffer_load_dwordx4 v219, s[20:23], s3 offen  lds
    s_mov_b64 exec, -1
    v_mov_b32 v108, 0
    v_mov_b32 v109, 0
    v_mov_b32 v110, 0
    v_mov_b32 v111, 0
    v_mov_b32 v160, 0
    v_mov_b32 v161, 0
    v_mov_b32 v162, 0
    v_mov_b32 v163, 0
    v_mov_b32 v164, 0
    v_mov_b32 v165, 0
    v_mov_b32 v166, 0
    v_mov_b32 v167, 0
    v_mov_b32 v168, 0
    v_mov_b32 v169, 0
    v_mov_b32 v170, 0
    v_mov_b32 v171, 0
    v_mov_b32 v172, 0
    v_mov_b32 v173, 0
    v_mov_b32 v174, 0
    v_mov_b32 v175, 0
    v_mov_b32 v176, 0
    v_mov_b32 v177, 0
    v_mov_b32 v178, 0
    v_mov_b32 v179, 0
    v_mov_b32 v180, 0
    v_mov_b32 v181, 0
    s_waitcnt vmcnt(7)
    s_barrier
    s_add_u32 m0, s35, 87040
    s_add_u32 s3, s31, 1310720
    buffer_load_dwordx4 v218, s[8:11], s3 offen  lds
    s_add_u32 s3, s3, 31744
    buffer_load_dwordx4 v218, s[8:11], s3 offen offset:1024  lds
    s_add_u32 s3, s33, 320
    buffer_load_dwordx4 v219, s[20:23], s3 offen offset:2048  lds
    s_add_u32 m0, s35, 99328
    s_add_u32 s3, s31, 1310976
    buffer_load_dwordx4 v218, s[8:11], s3 offen  lds
    s_add_u32 s3, s3, 31744
    buffer_load_dwordx4 v218, s[8:11], s3 offen offset:1024  lds
    s_add_u32 s3, s33, 74048
    buffer_load_dwordx4 v219, s[20:23], s3 offen offset:2048  lds
    s_mov_b32 m0, 111616
    s_mov_b32 s3, 149824
    s_mov_b64 exec, s[38:39]
    buffer_load_dwordx4 v219, s[20:23], s3 offen  lds
    s_mov_b64 exec, -1
    v_mov_b32 v182, 0
    v_mov_b32 v183, 0
    v_mov_b32 v184, 0
    v_mov_b32 v185, 0
    v_mov_b32 v186, 0
    v_mov_b32 v187, 0
    v_mov_b32 v188, 0
    v_mov_b32 v189, 0
    v_mov_b32 v190, 0
    v_mov_b32 v191, 0
    v_mov_b32 v212, 0
    v_mov_b32 v213, 0
    v_mov_b32 v214, 0
    v_mov_b32 v215, 0
    v_mov_b32 v63, 0
    v_mov_b32 v62, 0
    v_mov_b32 v61, 0
    v_mov_b32 v60, 0
    v_mov_b32 v59, 0
    v_mov_b32 v58, 0
    v_mov_b32 v57, 0
    v_mov_b32 v56, 0
    v_mov_b32 v55, 0
    v_mov_b32 v54, 0
    v_mov_b32 v53, 0
    v_mov_b32 v52, 0
    s_waitcnt vmcnt(7)
    s_barrier
    s_add_u32 m0, s35, 112640
    s_add_u32 s3, s31, 1572864
    buffer_load_dwordx4 v218, s[8:11], s3 offen  lds
    s_add_u32 s3, s3, 31744
    buffer_load_dwordx4 v218, s[8:11], s3 offen offset:1024  lds
    s_add_u32 s3, s33, 384
    buffer_load_dwordx4 v219, s[20:23], s3 offen offset:2048  lds
    s_add_u32 m0, s35, 124928
    s_add_u32 s3, s31, 1573120
    buffer_load_dwordx4 v218, s[8:11], s3 offen  lds
    s_add_u32 s3, s3, 31744
    buffer_load_dwordx4 v218, s[8:11], s3 offen offset:1024  lds
    s_add_u32 s3, s33, 74112
    buffer_load_dwordx4 v219, s[20:23], s3 offen offset:2048  lds
    s_mov_b32 m0, 137216
    s_mov_b32 s3, 149888
    s_mov_b64 exec, s[38:39]
    buffer_load_dwordx4 v219, s[20:23], s3 offen  lds
    s_mov_b64 exec, -1
    v_mov_b32 v51, 0
    v_mov_b32 v50, 0
    v_mov_b32 v49, 0
    v_mov_b32 v48, 0
    v_mov_b32 v47, 0
    v_mov_b32 v46, 0
    v_mov_b32 v45, 0
    v_mov_b32 v44, 0
    v_mov_b32 v43, 0
    v_mov_b32 v42, 0
    v_mov_b32 v41, 0
    v_mov_b32 v40, 0
    v_mov_b32 v39, 0
    v_mov_b32 v38, 0
    v_mov_b32 v37, 0
    v_mov_b32 v36, 0
    v_mov_b32 v35, 0
    v_mov_b32 v34, 0
    v_mov_b32 v33, 0
    v_mov_b32 v32, 0
    v_mov_b32 v31, 0
    v_mov_b32 v30, 0
    v_mov_b32 v29, 0
    v_mov_b32 v28, 0
    v_mov_b32 v27, 0
    v_mov_b32 v26, 0
    s_waitcnt vmcnt(7)
    s_barrier
    s_add_u32 m0, s35, 138240
    s_add_u32 s3, s31, 1835008
    buffer_load_dwordx4 v218, s[8:11], s3 offen  lds
    s_add_u32 s3, s3, 31744
    buffer_load_dwordx4 v218, s[8:11], s3 offen offset:1024  lds
    s_add_u32 s3, s33, 448
    buffer_load_dwordx4 v219, s[20:23], s3 offen offset:2048  lds
    s_add_u32 m0, s35, 150528
    s_add_u32 s3, s31, 1835264
    buffer_load_dwordx4 v218, s[8:11], s3 offen  lds
    s_add_u32 s3, s3, 31744
    buffer_load_dwordx4 v218, s[8:11], s3 offen offset:1024  lds
    s_add_u32 s3, s33, 74176
    buffer_load_dwordx4 v219, s[20:23], s3 offen offset:2048  lds
    s_mov_b32 m0, 162816
    s_mov_b32 s3, 149952
    s_mov_b64 exec, s[38:39]
    buffer_load_dwordx4 v219, s[20:23], s3 offen  lds
    s_mov_b64 exec, -1
    s_add_u32 m0, s35, 35840
    s_add_u32 s3, s31, 2097152
    buffer_load_dwordx4 v218, s[8:11], s3 offen  lds
    s_add_u32 s3, s3, 31744
    buffer_load_dwordx4 v218, s[8:11], s3 offen offset:1024  lds
    s_add_u32 s3, s33, 512
    buffer_load_dwordx4 v219, s[20:23], s3 offen offset:2048  lds
    s_add_u32 m0, s35, 48128
    s_add_u32 s3, s31, 2097408
    buffer_load_dwordx4 v218, s[8:11], s3 offen  lds
    s_add_u32 s3, s3, 31744
    buffer_load_dwordx4 v218, s[8:11], s3 offen offset:1024  lds
    s_add_u32 s3, s33, 74240
    buffer_load_dwordx4 v219, s[20:23], s3 offen offset:2048  lds
    s_mov_b32 m0, 60416
    s_mov_b32 s3, 150016
    s_mov_b64 exec, s[38:39]
    buffer_load_dwordx4 v219, s[20:23], s3 offen  lds
    s_mov_b64 exec, -1
    v_mov_b32 v25, 0
    v_mov_b32 v24, 0
    v_mov_b32 v23, 0
    v_mov_b32 v22, 0
    v_mov_b32 v21, 0
    v_mov_b32 v20, 0
    v_mov_b32 v19, 0
    v_mov_b32 v18, 0
    v_mov_b32 v17, 0
    v_mov_b32 v16, 0
    v_mov_b32 v15, 0
    v_mov_b32 v14, 0
    v_mov_b32 v13, 0
    v_mov_b32 v12, 0
    v_mov_b32 v11, 0
    v_mov_b32 v10, 0
    v_mov_b32 v9, 0
    v_mov_b32 v8, 0
    v_mov_b32 v7, 0
    v_mov_b32 v6, 0
    v_mov_b32 v5, 0
    v_mov_b32 v4, 0
    v_mov_b32 v3, 0
    v_mov_b32 v2, 0
    v_mov_b32 v1, 0
    v_mov_b32 v0, 0
    s_waitcnt vmcnt(14)
    s_barrier
    s_add_u32 m0, s35, 61440
    s_add_u32 s3, s31, 2359296
    buffer_load_dwordx4 v218, s[8:11], s3 offen  lds
    s_add_u32 s3, s3, 31744
    buffer_load_dwordx4 v218, s[8:11], s3 offen offset:1024  lds
    s_add_u32 s3, s33, 576
    buffer_load_dwordx4 v219, s[20:23], s3 offen offset:2048  lds
    s_add_u32 m0, s35, 73728
    s_add_u32 s3, s31, 2359552
    buffer_load_dwordx4 v218, s[8:11], s3 offen  lds
    s_add_u32 s3, s3, 31744
    buffer_load_dwordx4 v218, s[8:11], s3 offen offset:1024  lds
    s_add_u32 s3, s33, 74304
    buffer_load_dwordx4 v219, s[20:23], s3 offen offset:2048  lds
    s_mov_b32 m0, 86016
    s_mov_b32 s3, 150080
    s_mov_b64 exec, s[38:39]
    buffer_load_dwordx4 v219, s[20:23], s3 offen  lds
    s_mov_b64 exec, -1
    s_waitcnt vmcnt(14)
    s_barrier
    s_add_u32 m0, s35, 87040
    s_add_u32 s3, s31, 2621440
    buffer_load_dwordx4 v218, s[8:11], s3 offen  lds
    s_add_u32 s3, s3, 31744
    buffer_load_dwordx4 v218, s[8:11], s3 offen offset:1024  lds
    s_add_u32 s3, s33, 640
    buffer_load_dwordx4 v219, s[20:23], s3 offen offset:2048  lds
    s_add_u32 m0, s35, 99328
    s_add_u32 s3, s31, 2621696
    buffer_load_dwordx4 v218, s[8:11], s3 offen  lds
    s_add_u32 s3, s3, 31744
    buffer_load_dwordx4 v218, s[8:11], s3 offen offset:1024  lds
    s_add_u32 s3, s33, 74368
    buffer_load_dwordx4 v219, s[20:23], s3 offen offset:2048  lds
    s_mov_b32 m0, 111616
    s_mov_b32 s3, 150144
    s_mov_b64 exec, s[38:39]
    buffer_load_dwordx4 v219, s[20:23], s3 offen  lds
    s_mov_b64 exec, -1
    s_add_u32 m0, s35, 112640
    s_add_u32 s3, s31, 2883584
    buffer_load_dwordx4 v218, s[8:11], s3 offen  lds
    s_add_u32 s3, s3, 31744
    buffer_load_dwordx4 v218, s[8:11], s3 offen offset:1024  lds
    s_add_u32 s3, s33, 704
    buffer_load_dwordx4 v219, s[20:23], s3 offen offset:2048  lds
    s_add_u32 m0, s35, 124928
    s_add_u32 s3, s31, 2883840
    buffer_load_dwordx4 v218, s[8:11], s3 offen  lds
    s_add_u32 s3, s3, 31744
    buffer_load_dwordx4 v218, s[8:11], s3 offen offset:1024  lds
    s_add_u32 s3, s33, 74432
    buffer_load_dwordx4 v219, s[20:23], s3 offen offset:2048  lds
    s_mov_b32 m0, 137216
    s_mov_b32 s3, 150208
    s_mov_b64 exec, s[38:39]
    buffer_load_dwordx4 v219, s[20:23], s3 offen  lds
    s_mov_b64 exec, -1
    s_waitcnt vmcnt(21)
    s_barrier
    s_add_u32 m0, s35, 138240
    s_add_u32 s3, s31, 3145728
    buffer_load_dwordx4 v218, s[8:11], s3 offen  lds
    s_add_u32 s3, s3, 31744
    buffer_load_dwordx4 v218, s[8:11], s3 offen offset:1024  lds
    s_add_u32 s3, s33, 768
    buffer_load_dwordx4 v219, s[20:23], s3 offen offset:2048  lds
    s_add_u32 m0, s35, 150528
    s_add_u32 s3, s31, 3145984
    buffer_load_dwordx4 v218, s[8:11], s3 offen  lds
    s_add_u32 s3, s3, 31744
    buffer_load_dwordx4 v218, s[8:11], s3 offen offset:1024  lds
    s_add_u32 s3, s33, 74496
    buffer_load_dwordx4 v219, s[20:23], s3 offen offset:2048  lds
    s_mov_b32 m0, 162816
    s_mov_b32 s3, 150272
    s_mov_b64 exec, s[38:39]
    buffer_load_dwordx4 v219, s[20:23], s3 offen  lds
    s_mov_b64 exec, -1
    s_waitcnt vmcnt(21)
    s_barrier
    s_add_u32 m0, s35, 35840
    s_add_u32 s3, s31, 3407872
    buffer_load_dwordx4 v218, s[8:11], s3 offen  lds
    s_add_u32 s3, s3, 31744
    buffer_load_dwordx4 v218, s[8:11], s3 offen offset:1024  lds
    s_add_u32 s3, s33, 832
    buffer_load_dwordx4 v219, s[20:23], s3 offen offset:2048  lds
    s_add_u32 m0, s35, 48128
    s_add_u32 s3, s31, 3408128
    buffer_load_dwordx4 v218, s[8:11], s3 offen  lds
    s_add_u32 s3, s3, 31744
    buffer_load_dwordx4 v218, s[8:11], s3 offen offset:1024  lds
    s_add_u32 s3, s33, 74560
    buffer_load_dwordx4 v219, s[20:23], s3 offen offset:2048  lds
    s_mov_b32 m0, 60416
    s_mov_b32 s3, 150336
    s_mov_b64 exec, s[38:39]
    buffer_load_dwordx4 v219, s[20:23], s3 offen  lds
    s_mov_b64 exec, -1
    s_and_b32 s3, s47, 1
    s_cbranch_scc0 K1_ON615
    v_lshlrev_b32 v232, 7, v225
    v_add_u32 v232, s50, v232
    s_mov_b32 exec_hi, 0
    s_add_u32 s3, s49, 49152
    s_and_b32 s3, s3, 0x1ffff
    buffer_load_dword v234, v232, s[12:15], s3 offen
    s_add_u32 s3, s49, 114688
    s_and_b32 s3, s3, 0x1ffff
    s_add_u32 s3, s3, 131072
    buffer_load_dword v234, v232, s[12:15], s3 offen
    s_mov_b32 exec_hi, -1
K1_ON615:
    s_and_b32 s3, s47, 1
    s_cbranch_scc1 K1_BW629
    s_waitcnt vmcnt(21)
K1_BW629:
    s_waitcnt vmcnt(23)
    s_barrier
    s_add_u32 m0, s35, 61440
    s_add_u32 s3, s31, 3670016
    buffer_load_dwordx4 v218, s[8:11], s3 offen  lds
    s_add_u32 s3, s3, 31744
    buffer_load_dwordx4 v218, s[8:11], s3 offen offset:1024  lds
    s_add_u32 s3, s33, 896
    buffer_load_dwordx4 v219, s[20:23], s3 offen offset:2048  lds
    s_add_u32 m0, s35, 73728
    s_add_u32 s3, s31, 3670272
    buffer_load_dwordx4 v218, s[8:11], s3 offen  lds
    s_add_u32 s3, s3, 31744
    buffer_load_dwordx4 v218, s[8:11], s3 offen offset:1024  lds
    s_add_u32 s3, s33, 74624
    buffer_load_dwordx4 v219, s[20:23], s3 offen offset:2048  lds
    s_mov_b32 m0, 86016
    s_mov_b32 s3, 150400
    s_mov_b64 exec, s[38:39]
    buffer_load_dwordx4 v219, s[20:23], s3 offen  lds
    s_mov_b64 exec, -1
    s_and_b32 s3, s47, 2
    s_cbranch_scc0 K1_ON654
    v_lshlrev_b32 v232, 7, v225
    v_add_u32 v232, s50, v232
    s_mov_b32 exec_hi, 0
    s_add_u32 s3, s49, 49152
    s_and_b32 s3, s3, 0x1ffff
    buffer_load_dword v234, v232, s[12:15], s3 offen
    s_add_u32 s3, s49, 114688
    s_and_b32 s3, s3, 0x1ffff
    s_add_u32 s3, s3, 131072
    buffer_load_dword v234, v232, s[12:15], s3 offen
    s_mov_b32 exec_hi, -1
K1_ON654:
    s_and_b32 s3, s47, 3
    s_cbranch_scc1 K1_BW668
    s_waitcnt vmcnt(21)
K1_BW668:
    s_waitcnt vmcnt(23)
    s_barrier
    s_add_u32 m0, s35, 87040
    s_add_u32 s3, s31, 3932160
    buffer_load_dwordx4 v218, s[8:11], s3 offen  lds
    s_add_u32 s3, s3, 31744
    buffer_load_dwordx4 v218, s[8:11], s3 offen offset:1024  lds
    s_add_u32 s3, s33, 960
    buffer_load_dwordx4 v219, s[20:23], s3 offen offset:2048  lds
    s_add_u32 m0, s35, 99328
    s_add_u32 s3, s31, 3932416
    buffer_load_dwordx4 v218, s[8:11], s3 offen  lds
    s_add_u32 s3, s3, 31744
    buffer_load_dwordx4 v218, s[8:11], s3 offen offset:1024  lds
    s_add_u32 s3, s33, 74688
    buffer_load_dwordx4 v219, s[20:23], s3 offen offset:2048  lds
    s_mov_b32 m0, 111616
    s_mov_b32 s3, 150464
    s_mov_b64 exec, s[38:39]
    buffer_load_dwordx4 v219, s[20:23], s3 offen  lds
    s_mov_b64 exec, -1
    s_and_b32 s3, s47, 4
    s_cbranch_scc0 K1_ON693
    v_lshlrev_b32 v232, 7, v225
    v_add_u32 v232, s50, v232
    s_mov_b32 exec_hi, 0
    s_add_u32 s3, s49, 49152
    s_and_b32 s3, s3, 0x1ffff
    buffer_load_dword v234, v232, s[12:15], s3 offen
    s_add_u32 s3, s49, 114688
    s_and_b32 s3, s3, 0x1ffff
    s_add_u32 s3, s3, 131072
    buffer_load_dword v234, v232, s[12:15], s3 offen
    s_mov_b32 exec_hi, -1
K1_ON693:
    s_and_b32 s3, s47, 7
    s_cbranch_scc1 K1_BW707
    s_waitcnt vmcnt(21)
K1_BW707:
    s_waitcnt vmcnt(23)
    s_barrier
    s_add_u32 m0, s35, 112640
    s_add_u32 s3, s31, 4194304
    buffer_load_dwordx4 v218, s[8:11], s3 offen  lds
    s_add_u32 s3, s3, 31744
    buffer_load_dwordx4 v218, s[8:11], s3 offen offset:1024  lds
    s_add_u32 s3, s33, 1024
    buffer_load_dwordx4 v219, s[20:23], s3 offen offset:2048  lds
    s_add_u32 m0, s35, 124928
    s_add_u32 s3, s31, 4194560
    buffer_load_dwordx4 v218, s[8:11], s3 offen  lds
    s_add_u32 s3, s3, 31744
    buffer_load_dwordx4 v218, s[8:11], s3 offen offset:1024  lds
    s_add_u32 s3, s33, 74752
    buffer_load_dwordx4 v219, s[20:23], s3 offen offset:2048  lds
    s_mov_b32 m0, 137216
    s_mov_b32 s3, 150528
    s_mov_b64 exec, s[38:39]
    buffer_load_dwordx4 v219, s[20:23], s3 offen  lds
    s_mov_b64 exec, -1
    s_and_b32 s3, s47, 8
    s_cbranch_scc0 K1_ON732
    v_lshlrev_b32 v232, 7, v225
    v_add_u32 v232, s50, v232
    s_mov_b32 exec_hi, 0
    s_add_u32 s3, s49, 49152
    s_and_b32 s3, s3, 0x1ffff
    buffer_load_dword v234, v232, s[12:15], s3 offen
    s_add_u32 s3, s49, 114688
    s_and_b32 s3, s3, 0x1ffff
    s_add_u32 s3, s3, 131072
    buffer_load_dword v234, v232, s[12:15], s3 offen
    s_mov_b32 exec_hi, -1
K1_ON732:
    s_waitcnt vmcnt(23)
    s_barrier
    s_add_u32 m0, s35, 138240
    s_add_u32 s3, s31, 4456448
    buffer_load_dwordx4 v218, s[8:11], s3 offen  lds
    s_add_u32 s3, s3, 31744
    buffer_load_dwordx4 v218, s[8:11], s3 offen offset:1024  lds
    s_add_u32 s3, s33, 1088
    buffer_load_dwordx4 v219, s[20:23], s3 offen offset:2048  lds
    s_add_u32 m0, s35, 150528
    s_add_u32 s3, s31, 4456704
    buffer_load_dwordx4 v218, s[8:11], s3 offen  lds
    s_add_u32 s3, s3, 31744
    buffer_load_dwordx4 v218, s[8:11], s3 offen offset:1024  lds
    s_add_u32 s3, s33, 74816
    buffer_load_dwordx4 v219, s[20:23], s3 offen offset:2048  lds
    s_mov_b32 m0, 162816
    s_mov_b32 s3, 150592
    s_mov_b64 exec, s[38:39]
    buffer_load_dwordx4 v219, s[20:23], s3 offen  lds
    s_mov_b64 exec, -1
    s_cmp_eq_u32 s24, 0
    s_cbranch_scc0 K1_EPR
    s_mov_b64 exec, 1
    buffer_load_dword v144, v146, s[56:59], 0 offen sc1
    s_mov_b64 exec, -1
K1_EPR:
    s_add_u32 s3, s49, 0
    s_and_b32 s3, s3, 0x1ffff
    s_add_u32 m0, s50, 0
    s_nop 0
    buffer_load_dwordx4 v220, s[12:15], s3 offen offset:0 nt lds
    s_add_u32 s3, s49, 0
    s_and_b32 s3, s3, 0x1ffff
    s_add_u32 m0, s50, 0
    s_nop 0
    buffer_load_dwordx4 v220, s[12:15], s3 offen offset:1024 nt lds
    s_add_u32 s3, s49, 0
    s_and_b32 s3, s3, 0x1ffff
    s_add_u32 m0, s50, 0
    s_nop 0
    buffer_load_dwordx4 v220, s[12:15], s3 offen offset:2048 nt lds
    s_add_u32 s3, s49, 0
    s_and_b32 s3, s3, 0x1ffff
    s_add_u32 m0, s50, 0
    s_nop 0
    buffer_load_dwordx4 v220, s[12:15], s3 offen offset:3072 nt lds
    s_and_b32 s3, s47, 14
    s_cbranch_scc1 K1_BW793
    s_waitcnt vmcnt(25)
K1_BW793:
    s_waitcnt vmcnt(27)
    s_barrier
    s_add_u32 s3, s49, 65536
    s_and_b32 s3, s3, 0x1ffff
    s_add_u32 s3, s3, 131072
    s_add_u32 m0, s50, 16384
    s_nop 0
    buffer_load_dwordx4 v220, s[12:15], s3 offen offset:0 nt lds
    s_add_u32 s3, s49, 65536
    s_and_b32 s3, s3, 0x1ffff
    s_add_u32 s3, s3, 131072
    s_add_u32 m0, s50, 16384
    s_nop 0
    buffer_load_dwordx4 v220, s[12:15], s3 offen offset:1024 nt lds
    s_add_u32 s3, s49, 65536
    s_and_b32 s3, s3, 0x1ffff
    s_add_u32 s3, s3, 131072
    s_add_u32 m0, s50, 16384
    s_nop 0
    buffer_load_dwordx4 v220, s[12:15], s3 offen offset:2048 nt lds
    s_add_u32 s3, s49, 65536
    s_and_b32 s3, s3, 0x1ffff
    s_add_u32 s3, s3, 131072
    s_add_u32 m0, s50, 16384
    s_nop 0
    buffer_load_dwordx4 v220, s[12:15], s3 offen offset:3072 nt lds
    s_and_b32 s3, s47, 12
    s_cbranch_scc1 K1_BW823
    s_waitcnt vmcnt(22)
K1_BW823:
    s_waitcnt vmcnt(24)
    s_barrier
    s_add_u32 s3, s49, 16384
    s_and_b32 s3, s3, 0x1ffff
    s_add_u32 m0, s50, 32768
    s_nop 0
    buffer_load_dwordx4 v220, s[12:15], s3 offen offset:0 nt lds
    s_add_u32 s3, s49, 16384
    s_and_b32 s3, s3, 0x1ffff
    s_add_u32 m0, s50, 32768
    s_nop 0
    buffer_load_dwordx4 v220, s[12:15], s3 offen offset:1024 nt lds
    s_add_u32 s3, s49, 16384
    s_and_b32 s3, s3, 0x1ffff
    s_add_u32 m0, s50, 32768
    s_nop 0
    buffer_load_dwordx4 v220, s[12:15], s3 offen offset:2048 nt lds
    s_add_u32 s3, s49, 16384
    s_and_b32 s3, s3, 0x1ffff
    s_add_u32 m0, s50, 32768
    s_nop 0
    buffer_load_dwordx4 v220, s[12:15], s3 offen offset:3072 nt lds
    s_and_b32 s3, s47, 8
    s_cbranch_scc1 K1_BW849
    s_waitcnt vmcnt(19)
K1_BW849:
    s_waitcnt vmcnt(21)
    s_barrier
    s_add_u32 s3, s49, 81920
    s_and_b32 s3, s3, 0x1ffff
    s_add_u32 s3, s3, 131072
    s_add_u32 m0, s50, 49152
    s_nop 0
    buffer_load_dwordx4 v220, s[12:15], s3 offen offset:0 nt lds
    s_add_u32 s3, s49, 81920
    s_and_b32 s3, s3, 0x1ffff
    s_add_u32 s3, s3, 131072
    s_add_u32 m0, s50, 49152
    s_nop 0
    buffer_load_dwordx4 v220, s[12:15], s3 offen offset:1024 nt lds
    s_add_u32 s3, s49, 81920
    s_and_b32 s3, s3, 0x1ffff
    s_add_u32 s3, s3, 131072
    s_add_u32 m0, s50, 49152
    s_nop 0
    buffer_load_dwordx4 v220, s[12:15], s3 offen offset:2048 nt lds
    s_add_u32 s3, s49, 81920
    s_and_b32 s3, s3, 0x1ffff
    s_add_u32 s3, s3, 131072
    s_add_u32 m0, s50, 49152
    s_nop 0
    buffer_load_dwordx4 v220, s[12:15], s3 offen offset:3072 nt lds
    s_add_u32 s3, s49, 0
    s_and_b32 s3, s3, 0x1ffff
    s_add_u32 m0, s50, 65536
    s_nop 0
    buffer_load_dwordx4 v221, s[16:19], s3 offen offset:0 nt lds
    s_add_u32 s3, s49, 0
    s_and_b32 s3, s3, 0x1ffff
    s_add_u32 m0, s50, 65536
    s_nop 0
    buffer_load_dwordx4 v221, s[16:19], s3 offen offset:1024 nt lds
    s_waitcnt vmcnt(18)
    s_barrier
    s_barrier
    s_cmp_eq_u32 s24, 0
    s_cbranch_scc0 K1_EP18
    s_mov_b64 exec, 1
    s_mov_b32 s6, 200000
    s_waitcnt vmcnt(18)
K1_EPW:
    v_cmp_ne_u32 vcc, 0, v144
    s_cbranch_vccnz K1_EPG
    buffer_load_dword v144, v146, s[56:59], 0 offen sc1
    s_sub_u32 s6, s6, 1
    s_waitcnt vmcnt(0)
    s_cbranch_scc0 K1_EPW
K1_EPG:
    v_mov_b32 v146, 123392
    ds_write_b32 v146, v144
    s_getreg_b32 s3, hwreg(HW_REG_XCC_ID, 0, 4)
    v_lshl_add_u32 v145, v144, 4, s3
    s_and_b32 s3, s2, 7
    s_lshl_b32 s3, s3, 3
    s_add_u32 s3, s3, s27
    s_lshl_b32 s3, s3, 5
    s_and_b32 s7, s28, 3
    s_add_u32 s3, s3, s7
    s_lshl_b32 s3, s3, 2
    v_mov_b32 v146, s3
    buffer_store_dword v145, v146, s[52:55], 0 offen offset:32 sc1
    s_mov_b64 exec, -1
K1_EP18:
    s_add_u32 s3, s49, 0
    s_and_b32 s3, s3, 0x1ffff
    s_add_u32 m0, s50, 65536
    s_nop 0
    buffer_load_dwordx4 v221, s[16:19], s3 offen offset:2048 nt lds
    s_add_u32 s3, s49, 0
    s_and_b32 s3, s3, 0x1ffff
    s_add_u32 m0, s50, 65536
    s_nop 0
    buffer_load_dwordx4 v221, s[16:19], s3 offen offset:3072 nt lds
    s_add_u32 s3, s49, 65536
    s_and_b32 s3, s3, 0x1ffff
    s_add_u32 s3, s3, 131072
    s_add_u32 m0, s50, 81920
    s_nop 0
    buffer_load_dwordx4 v221, s[16:19], s3 offen offset:0 nt lds
    s_add_u32 s3, s49, 65536
    s_and_b32 s3, s3, 0x1ffff
    s_add_u32 s3, s3, 131072
    s_add_u32 m0, s50, 81920
    s_nop 0
    buffer_load_dwordx4 v221, s[16:19], s3 offen offset:1024 nt lds
    s_add_u32 s3, s49, 65536
    s_and_b32 s3, s3, 0x1ffff
    s_add_u32 s3, s3, 131072
    s_add_u32 m0, s50, 81920
    s_nop 0
    buffer_load_dwordx4 v221, s[16:19], s3 offen offset:2048 nt lds
    s_add_u32 s3, s49, 65536
    s_and_b32 s3, s3, 0x1ffff
    s_add_u32 s3, s3, 131072
    s_add_u32 m0, s50, 81920
    s_nop 0
    buffer_load_dwordx4 v221, s[16:19], s3 offen offset:3072 nt lds
    s_add_u32 s3, s49, 32768
    s_and_b32 s3, s3, 0x1ffff
    s_add_u32 m0, s50, 98304
    s_nop 0
    buffer_load_dwordx4 v220, s[12:15], s3 offen offset:0 nt lds
    s_add_u32 s3, s49, 32768
    s_and_b32 s3, s3, 0x1ffff
    s_add_u32 m0, s50, 98304
    s_nop 0
    buffer_load_dwordx4 v220, s[12:15], s3 offen offset:1024 nt lds
    s_add_u32 s3, s49, 32768
    s_and_b32 s3, s3, 0x1ffff
    s_add_u32 m0, s50, 98304
    s_nop 0
    buffer_load_dwordx4 v220, s[12:15], s3 offen offset:2048 nt lds
    s_add_u32 s3, s49, 32768
    s_and_b32 s3, s3, 0x1ffff
    s_add_u32 m0, s50, 98304
    s_nop 0
    buffer_load_dwordx4 v220, s[12:15], s3 offen offset:3072 nt lds
    v_mov_b32 v96, 0
    v_mov_b32 v97, 0
    v_mov_b32 v98, 0
    v_mov_b32 v99, 0
    v_mov_b32 v100, 0
    v_mov_b32 v101, 0
    v_mov_b32 v102, 0
    v_mov_b32 v103, 0
    v_mov_b32 v104, 0
    v_mov_b32 v105, 0
    v_mov_b32 v106, 0
    v_mov_b32 v107, 0
    v_mov_b32 v218, 0
    v_mov_b32 v219, 0
    s_mov_b32 s30, 1
    s_mov_b32 s51, 32768
    s_mov_b32 s32, 65536
    s_mov_b32 s43, 32768
    s_mov_b32 s44, 0
    s_mov_b32 s40, 131072
    s_mov_b32 s31, 0
    s_mov_b32 s33, 0
    s_mul_i32 s3, s26, 65536
    s_add_u32 s3, s3, s49
    s_add_u32 s42, s3, 16384
    s_and_b32 s42, s42, 0x1ffff
    s_add_u32 s41, s3, 49152
    s_and_b32 s41, s41, 0x1ffff
    s_mov_b32 s46, 0xff800000
    s_mov_b32 s47, 0
    s_waitcnt vmcnt(20)
    s_waitcnt lgkmcnt(0)
    s_barrier
    v_mov_b32 v232, 123392
    ds_read_b32 v232, v232
    ds_read_b128 v[112:115], v209 offset:0
    ds_read_b128 v[116:119], v209 offset:1024
    ds_read_b128 v[120:123], v209 offset:2048
    ds_read_b128 v[124:127], v209 offset:3072
    ds_read_b128 v[128:131], v209 offset:4096
    ds_read_b128 v[132:135], v209 offset:5120
    ds_read_b128 v[136:139], v209 offset:6144
    ds_read_b128 v[140:143], v209 offset:7168
    ds_read_b128 v[192:195], v208 offset:0
    ds_read_b128 v[196:199], v208 offset:64
    ds_read_b128 v[200:203], v208 offset:128
    ds_read_b128 v[204:207], v208 offset:192
    s_waitcnt lgkmcnt(0)
    s_barrier
    v_readfirstlane_b32 s34, v232
    s_add_u32 s3, s49, 98304
    s_and_b32 s3, s3, 0x1ffff
    s_add_u32 s3, s3, 131072
    s_add_u32 m0, s50, 114688
    s_nop 0
    buffer_load_dwordx4 v220, s[12:15], s3 offen offset:0 nt lds
    s_add_u32 s3, s49, 98304
    s_and_b32 s3, s3, 0x1ffff
    s_add_u32 s3, s3, 131072
    s_add_u32 m0, s50, 114688
    s_nop 0
    buffer_load_dwordx4 v220, s[12:15], s3 offen offset:1024 nt lds
    s_add_u32 s3, s49, 98304
    s_and_b32 s3, s3, 0x1ffff
    s_add_u32 s3, s3, 131072
    s_add_u32 m0, s50, 114688
    s_nop 0
    buffer_load_dwordx4 v220, s[12:15], s3 offen offset:2048 nt lds
    s_add_u32 s3, s49, 98304
    s_and_b32 s3, s3, 0x1ffff
    s_add_u32 s3, s3, 131072
    s_add_u32 m0, s50, 114688
    s_nop 0
    buffer_load_dwordx4 v220, s[12:15], s3 offen offset:3072 nt lds
    s_lshl_b32 s3, s26, 17
    s_add_u32 s12, s12, s3
    s_addc_u32 s13, s13, 0
    s_add_u32 s16, s16, s3
    s_addc_u32 s17, s17, 0
    s_mov_b32 s14, 131072
    s_mov_b32 s18, 131072
    s_branch K1_HEAD
K1_G1:
    s_add_u32 s12, s58, s48
    s_addc_u32 s13, s59, 0
    s_add_u32 s16, s60, s48
    s_addc_u32 s17, s61, 0
    s_lshr_b32 s49, s2, 3
    s_mul_i32 s3, s2, 0
    s_mul_i32 s49, s49, 1
    s_add_u32 s49, s49, s3
    s_lshl_b32 s49, s49, 14
    s_add_u32 s52, s66, 50331648
    s_addc_u32 s53, s67, 0
    s_mov_b32 s54, 32768
    s_mov_b32 s55, 0x20000
    v_bfe_u32 v10, v225, 2, 2
    v_and_b32 v11, 3, v225
    v_lshrrev_b32 v12, 5, v225
    v_and_b32 v13, 1, v2
    v_and_b32 v20, 1, v11
    v_lshrrev_b32 v15, 1, v11
    v_lshlrev_b32 v16, 2, v10
    v_lshl_add_u32 v17, v13, 1, v20
    v_xor_b32 v17, v17, v16
    v_lshlrev_b32 v17, 4, v17
    v_lshl_add_u32 v17, v15, 3, v17
    v_lshl_add_u32 v17, v10, 8, v17
    s_lshl_b32 s3, s26, 14
    s_add_u32 s50, s50, s3
    s_add_u32 s6, s3, 65536
    v_lshl_add_u32 v18, v12, 10, v17
    v_add_u32 v226, s6, v18
    v_xor_b32 v227, 64, v226
    v_xor_b32 v228, 0x80, v226
    v_xor_b32 v229, 0xc0, v226
    v_bfe_u32 v23, v225, 3, 2
    v_bfe_u32 v24, v225, 2, 1
    v_lshl_add_u32 v25, v23, 2, v11
    v_xor_b32 v25, v25, v12
    v_lshlrev_b32 v25, 4, v25
    v_lshl_add_u32 v25, v11, 8, v25
    v_lshl_add_u32 v25, v24, 10, v25
    v_lshl_add_u32 v25, v23, 12, v25
    v_add_u32 v222, s3, v25
    s_lshl_b32 s7, s25, 10
    s_add_u32 s6, s3, s7
    v_xor_b32 v25, v2, v3
    v_lshlrev_b32 v25, 4, v25
    v_lshl_add_u32 v25, v11, 8, v25
    v_lshl_add_u32 v25, v10, 12, v25
    v_add_u32 v223, s6, v25
    v_xor_b32 v25, v15, v16
    v_lshlrev_b32 v25, 4, v25
    v_lshl_add_u32 v25, v20, 3, v25
    v_lshl_add_u32 v25, v10, 8, v25
    v_lshl_add_u32 v25, v2, 12, v25
    s_add_u32 s6, s6, 65536
    s_lshl_b32 s7, s25, 6
    v_xor_b32 v25, s7, v25
    v_add_u32 v224, s6, v25
    v_mul_u32_u24 v26, 272, v3
    v_lshl_add_u32 v27, v2, 4, v26
    s_mul_i32 s6, s26, 4352
    s_add_u32 s6, s6, 114688
    v_add_u32 v208, s6, v27
    v_lshlrev_b32 v27, 4, v225
    s_lshl_b32 s6, s25, 13
    s_add_u32 s6, s6, 131072
    v_add_u32 v209, s6, v27
    v_mul_u32_u24 v18, 3072, v12
    v_add_u32 v18, 87040, v18
    v_add_u32 v230, v17, v18
    v_xor_b32 v231, 64, v230
    v_xor_b32 v232, 0x80, v230
    v_xor_b32 v233, 0xc0, v230
    s_lshl_b32 s6, s25, 2
    v_add_u32 v18, s6, v15
    v_xor_b32 v18, v18, v16
    v_lshlrev_b32 v18, 4, v18
    v_lshl_add_u32 v18, v20, 3, v18
    v_lshl_add_u32 v18, v10, 8, v18
    v_mul_u32_u24 v19, 3072, v2
    v_add_u32 v19, 87040, v19
    v_add_u32 v217, v18, v19
    v_xor_b32 v22, v12, v10
    v_lshlrev_b32 v22, 4, v22
    v_lshl_add_u32 v22, v3, 6, v22
    v_mul_u32_u24 v19, 3072, v13
    s_mul_i32 s6, s25, 6144
    s_add_u32 s6, s6, 89088
    v_add3_u32 v234, v22, v19, s6
    v_xor_b32 v235, 32, v234
    v_xor_b32 v22, v2, v10
    v_lshlrev_b32 v22, 4, v22
    v_lshl_add_u32 v22, v3, 6, v22
    v_add_u32 v216, 111616, v22
    v_lshl_add_u32 v27, v2, 3, v26
    s_lshl_b32 s6, s25, 6
    s_add_u32 s6, s6, 114688
    v_add_u32 v210, s6, v27
    v_mov_b32 v212, 0
    v_mov_b32 v213, 0
    v_mov_b32 v214, 0
    v_mov_b32 v215, 0
    v_mov_b32 v108, 0
    v_mov_b32 v109, 0
    v_mov_b32 v110, 0
    v_mov_b32 v111, 0
    v_mov_b32 v218, 0
    v_mov_b32 v219, 0
    v_mov_b32 v0, 0
    v_mov_b32 v1, 0
    v_mov_b32 v2, 0
    v_mov_b32 v3, 0
    v_mov_b32 v4, 0
    v_mov_b32 v5, 0
    v_mov_b32 v6, 0
    v_mov_b32 v7, 0
    v_mov_b32 v8, 0
    v_mov_b32 v9, 0
    v_mov_b32 v10, 0
    v_mov_b32 v11, 0
    v_mov_b32 v12, 0
    v_mov_b32 v13, 0
    v_mov_b32 v14, 0
    v_mov_b32 v15, 0
    v_mov_b32 v16, 0
    v_mov_b32 v17, 0
    v_mov_b32 v18, 0
    v_mov_b32 v19, 0
    v_mov_b32 v20, 0
    v_mov_b32 v21, 0
    v_mov_b32 v22, 0
    v_mov_b32 v23, 0
    v_mov_b32 v24, 0
    v_mov_b32 v25, 0
    v_mov_b32 v26, 0
    v_mov_b32 v27, 0
    v_mov_b32 v28, 0
    v_mov_b32 v29, 0
    v_mov_b32 v30, 0
    v_mov_b32 v31, 0
    v_mov_b32 v32, 0
    v_mov_b32 v33, 0
    v_mov_b32 v34, 0
    v_mov_b32 v35, 0
    v_mov_b32 v36, 0
    v_mov_b32 v37, 0
    v_mov_b32 v38, 0
    v_mov_b32 v39, 0
    v_mov_b32 v40, 0
    v_mov_b32 v41, 0
    v_mov_b32 v42, 0
    v_mov_b32 v43, 0
    v_mov_b32 v44, 0
    v_mov_b32 v45, 0
    v_mov_b32 v46, 0
    v_mov_b32 v47, 0
    v_mov_b32 v48, 0
    v_mov_b32 v49, 0
    v_mov_b32 v50, 0
    v_mov_b32 v51, 0
    v_mov_b32 v52, 0
    v_mov_b32 v53, 0
    v_mov_b32 v54, 0
    v_mov_b32 v55, 0
    v_mov_b32 v56, 0
    v_mov_b32 v57, 0
    v_mov_b32 v58, 0
    v_mov_b32 v59, 0
    v_mov_b32 v60, 0
    v_mov_b32 v61, 0
    v_mov_b32 v62, 0
    v_mov_b32 v63, 0
    v_mov_b32 v160, 0
    v_mov_b32 v161, 0
    v_mov_b32 v162, 0
    v_mov_b32 v163, 0
    v_mov_b32 v164, 0
    v_mov_b32 v165, 0
    v_mov_b32 v166, 0
    v_mov_b32 v167, 0
    v_mov_b32 v64, 0
    v_mov_b32 v65, 0
    v_mov_b32 v66, 0
    v_mov_b32 v67, 0
    v_mov_b32 v68, 0
    v_mov_b32 v69, 0
    v_mov_b32 v70, 0
    v_mov_b32 v71, 0
    v_mov_b32 v72, 0
    v_mov_b32 v73, 0
    v_mov_b32 v74, 0
    v_mov_b32 v75, 0
    v_mov_b32 v76, 0
    v_mov_b32 v77, 0
    v_mov_b32 v78, 0
    v_mov_b32 v79, 0
    v_mov_b32 v80, 0
    v_mov_b32 v81, 0
    v_mov_b32 v82, 0
    v_mov_b32 v83, 0
    v_mov_b32 v84, 0
    v_mov_b32 v85, 0
    v_mov_b32 v86, 0
    v_mov_b32 v87, 0
    v_mov_b32 v88, 0
    v_mov_b32 v89, 0
    v_mov_b32 v90, 0
    v_mov_b32 v91, 0
    v_mov_b32 v92, 0
    v_mov_b32 v93, 0
    v_mov_b32 v94, 0
    v_mov_b32 v95, 0
    v_mov_b32 v144, 0
    v_mov_b32 v145, 0
    v_mov_b32 v146, 0
    v_mov_b32 v147, 0
    v_mov_b32 v148, 0
    v_mov_b32 v149, 0
    v_mov_b32 v150, 0
    v_mov_b32 v151, 0
    v_mov_b32 v152, 0
    v_mov_b32 v153, 0
    v_mov_b32 v154, 0
    v_mov_b32 v155, 0
    v_mov_b32 v156, 0
    v_mov_b32 v157, 0
    v_mov_b32 v158, 0
    v_mov_b32 v159, 0
    v_mov_b32 v176, 0
    v_mov_b32 v177, 0
    v_mov_b32 v178, 0
    v_mov_b32 v179, 0
    v_mov_b32 v180, 0
    v_mov_b32 v181, 0
    v_mov_b32 v182, 0
    v_mov_b32 v183, 0
    v_mov_b32 v184, 0
    v_mov_b32 v185, 0
    v_mov_b32 v186, 0
    v_mov_b32 v187, 0
    v_mov_b32 v188, 0
    v_mov_b32 v189, 0
    v_mov_b32 v190, 0
    v_mov_b32 v191, 0
    v_mov_b32 v168, 0
    v_mov_b32 v169, 0
    v_mov_b32 v170, 0
    v_mov_b32 v171, 0
    v_mov_b32 v172, 0
    v_mov_b32 v173, 0
    v_mov_b32 v174, 0
    v_mov_b32 v175, 0
    s_mov_b32 s36, 2
    s_barrier
    ds_read_b128 v[96:99], v234
    ds_read_b64_tr_b16 v[112:113], v230 offset:0
    ds_read_b64_tr_b16 v[114:115], v230 offset:1024
    ds_read_b64_tr_b16 v[116:117], v231 offset:0
    ds_read_b64_tr_b16 v[118:119], v231 offset:1024
    ds_read_b64_tr_b16 v[120:121], v232 offset:0
    ds_read_b64_tr_b16 v[122:123], v232 offset:1024
    ds_read_b64_tr_b16 v[124:125], v233 offset:0
    ds_read_b64_tr_b16 v[126:127], v233 offset:1024
    ds_read_b128 v[104:107], v216
    ds_read_b64_tr_b16 v[128:129], v230 offset:12288
    ds_read_b64_tr_b16 v[130:131], v230 offset:13312
    ds_read_b64_tr_b16 v[132:133], v231 offset:12288
    ds_read_b64_tr_b16 v[134:135], v231 offset:13312
    ds_read_b64_tr_b16 v[136:137], v232 offset:12288
    ds_read_b64_tr_b16 v[138:139], v232 offset:13312
    ds_read_b64_tr_b16 v[140:141], v233 offset:12288
    ds_read_b64_tr_b16 v[142:143], v233 offset:13312
    ds_read_b64_tr_b16 v[236:237], v217 offset:0
    ds_read_b64_tr_b16 v[238:239], v217 offset:1024
    ds_read_b64_tr_b16 v[240:241], v217 offset:32
    ds_read_b64_tr_b16 v[242:243], v217 offset:1056
    s_branch K1_QM
K1_QL:
    s_waitcnt lgkmcnt(0)
    s_barrier
    v_mfma_f32_32x32x16_bf16 v[32:47], v[128:131], v[100:103], v[32:47]
    ds_read_b128 v[96:99], v234
    ds_read_b64_tr_b16 v[112:113], v230 offset:0
    ds_read_b64_tr_b16 v[114:115], v230 offset:1024
    ds_read_b64_tr_b16 v[116:117], v231 offset:0
    v_mfma_f32_32x32x16_bf16 v[48:63], v[132:135], v[100:103], v[48:63]
    ds_read_b64_tr_b16 v[118:119], v231 offset:1024
    ds_read_b64_tr_b16 v[120:121], v232 offset:0
    ds_read_b64_tr_b16 v[122:123], v232 offset:1024
    ds_read_b64_tr_b16 v[124:125], v233 offset:0
    v_mfma_f32_32x32x16_bf16 v[64:79], v[136:139], v[100:103], v[64:79]
    ds_read_b64_tr_b16 v[126:127], v233 offset:1024
    ds_read_b64_tr_b16 v[128:129], v230 offset:12288
    ds_read_b64_tr_b16 v[130:131], v230 offset:13312
    ds_read_b64_tr_b16 v[132:133], v231 offset:12288
    v_mfma_f32_32x32x16_bf16 v[80:95], v[140:143], v[100:103], v[80:95]
    ds_read_b64_tr_b16 v[134:135], v231 offset:13312
    ds_read_b64_tr_b16 v[136:137], v232 offset:12288
    ds_read_b64_tr_b16 v[138:139], v232 offset:13312
    ds_read_b64_tr_b16 v[140:141], v233 offset:12288
    v_mfma_f32_32x32x16_bf16 v[144:159], v[236:239], v[100:103], v[144:159]
    ds_read_b64_tr_b16 v[142:143], v233 offset:13312
    ds_read_b64_tr_b16 v[236:237], v217 offset:0
    ds_read_b64_tr_b16 v[238:239], v217 offset:1024
    ds_read_b128 v[104:107], v216
    v_mfma_f32_32x32x16_bf16 v[176:191], v[240:243], v[100:103], v[176:191]
    ds_read_b64_tr_b16 v[240:241], v217 offset:32
    ds_read_b64_tr_b16 v[242:243], v217 offset:1056
K1_QM:
    s_waitcnt lgkmcnt(15)
    v_mfma_f32_32x32x16_bf16 v[0:15], v[112:115], v[96:99], v[0:15]
    ds_read_b64_tr_b16 v[112:113], v217 offset:12288
    ds_read_b64_tr_b16 v[114:115], v217 offset:13312
    ds_read_b128 v[100:103], v235
    v_mfma_f32_32x32x16_bf16 v[16:31], v[116:119], v[96:99], v[16:31]
    ds_read_b64_tr_b16 v[116:117], v217 offset:12320
    ds_read_b64_tr_b16 v[118:119], v217 offset:13344
    s_waitcnt lgkmcnt(15)
    v_mfma_f32_32x32x16_bf16 v[32:47], v[120:123], v[96:99], v[32:47]
    ds_read_b64_tr_b16 v[120:121], v230 offset:6144
    ds_read_b64_tr_b16 v[122:123], v230 offset:7168
    s_cmp_eq_u32 s36, 4
    s_mov_b32 s37, 25600
    s_cmov_b32 s37, 4294864896
    v_mfma_f32_32x32x16_bf16 v[48:63], v[124:127], v[96:99], v[48:63]
    ds_read_b64_tr_b16 v[124:125], v231 offset:6144
    ds_read_b64_tr_b16 v[126:127], v231 offset:7168
    s_waitcnt lgkmcnt(15)
    v_mfma_f32_32x32x16_bf16 v[64:79], v[128:131], v[96:99], v[64:79]
    ds_read_b64_tr_b16 v[128:129], v232 offset:6144
    ds_read_b64_tr_b16 v[130:131], v232 offset:7168
    s_add_u32 s36, s36, 1
    s_cmp_eq_u32 s36, 5
    s_cselect_b32 s36, 0, s36
    v_mfma_f32_32x32x16_bf16 v[80:95], v[132:135], v[96:99], v[80:95]
    ds_read_b64_tr_b16 v[132:133], v233 offset:6144
    ds_read_b64_tr_b16 v[134:135], v233 offset:7168
    s_waitcnt lgkmcnt(15)
    v_mfma_f32_32x32x16_bf16 v[144:159], v[136:139], v[96:99], v[144:159]
    ds_read_b64_tr_b16 v[136:137], v230 offset:18432
    ds_read_b64_tr_b16 v[138:139], v230 offset:19456
    v_mfma_f32_32x32x16_bf16 v[176:191], v[140:143], v[96:99], v[176:191]
    ds_read_b64_tr_b16 v[140:141], v231 offset:18432
    ds_read_b64_tr_b16 v[142:143], v231 offset:19456
    s_waitcnt lgkmcnt(15)
    v_mfma_f32_16x16x32_bf16 v[160:163], v[236:239], v[104:107], v[160:163]
    ds_read_b64_tr_b16 v[236:237], v232 offset:18432
    ds_read_b64_tr_b16 v[238:239], v232 offset:19456
    v_mfma_f32_16x16x32_bf16 v[164:167], v[240:243], v[104:107], v[164:167]
    ds_read_b64_tr_b16 v[240:241], v233 offset:18432
    ds_read_b64_tr_b16 v[242:243], v233 offset:19456
    s_waitcnt lgkmcnt(15)
    v_mfma_f32_16x16x32_bf16 v[168:171], v[112:115], v[104:107], v[168:171]
    v_add_u32 v230, s37, v230
    v_add_u32 v231, s37, v231
    v_add_u32 v232, s37, v232
    v_add_u32 v233, s37, v233
    v_mfma_f32_16x16x32_bf16 v[172:175], v[116:119], v[104:107], v[172:175]
    v_add_u32 v234, s37, v234
    v_add_u32 v235, s37, v235
    v_add_u32 v216, s37, v216
    v_add_u32 v217, s37, v217
    s_add_u32 s30, s30, 1
    s_cmp_lt_u32 s30, 18
    s_waitcnt lgkmcnt(12)
    v_mfma_f32_32x32x16_bf16 v[0:15], v[120:123], v[100:103], v[0:15]
    v_mfma_f32_32x32x16_bf16 v[16:31], v[124:127], v[100:103], v[16:31]
    s_cbranch_scc1 K1_QL
K1_QE:
    s_waitcnt lgkmcnt(0)
    s_barrier
    v_mfma_f32_32x32x16_bf16 v[32:47], v[128:131], v[100:103], v[32:47]
    v_mfma_f32_32x32x16_bf16 v[48:63], v[132:135], v[100:103], v[48:63]
    v_mfma_f32_32x32x16_bf16 v[64:79], v[136:139], v[100:103], v[64:79]
    v_mfma_f32_32x32x16_bf16 v[80:95], v[140:143], v[100:103], v[80:95]
    v_mfma_f32_32x32x16_bf16 v[144:159], v[236:239], v[100:103], v[144:159]
    v_mfma_f32_32x32x16_bf16 v[176:191], v[240:243], v[100:103], v[176:191]
    s_mov_b32 s6, 1040356334
    v_mul_f32 v160, s6, v160
    v_mul_f32 v161, s6, v161
    v_mul_f32 v162, s6, v162
    v_mul_f32 v163, s6, v163
    v_cvt_pk_bf16_f32 v160, v160, v161
    v_cvt_pk_bf16_f32 v161, v162, v163
    ds_write_b64 v210, v[160:161] offset:0
    v_mul_f32 v164, s6, v164
    v_mul_f32 v165, s6, v165
    v_mul_f32 v166, s6, v166
    v_mul_f32 v167, s6, v167
    v_cvt_pk_bf16_f32 v164, v164, v165
    v_cvt_pk_bf16_f32 v165, v166, v167
    ds_write_b64 v210, v[164:165] offset:32
    v_mul_f32 v168, s6, v168
    v_mul_f32 v169, s6, v169
    v_mul_f32 v170, s6, v170
    v_mul_f32 v171, s6, v171
    v_cvt_pk_bf16_f32 v168, v168, v169
    v_cvt_pk_bf16_f32 v169, v170, v171
    ds_write_b64 v210, v[168:169] offset:4352
    v_mul_f32 v172, s6, v172
    v_mul_f32 v173, s6, v173
    v_mul_f32 v174, s6, v174
    v_mul_f32 v175, s6, v175
    v_cvt_pk_bf16_f32 v172, v172, v173
    v_cvt_pk_bf16_f32 v173, v174, v175
    ds_write_b64 v210, v[172:173] offset:4384
    v_mul_f32 v0, s6, v0
    v_mul_f32 v1, s6, v1
    v_mul_f32 v2, s6, v2
    v_mul_f32 v3, s6, v3
    v_mul_f32 v4, s6, v4
    v_mul_f32 v5, s6, v5
    v_mul_f32 v6, s6, v6
    v_mul_f32 v7, s6, v7
    v_mul_f32 v8, s6, v8
    v_mul_f32 v9, s6, v9
    v_mul_f32 v10, s6, v10
    v_mul_f32 v11, s6, v11
    v_mul_f32 v12, s6, v12
    v_mul_f32 v13, s6, v13
    v_mul_f32 v14, s6, v14
    v_mul_f32 v15, s6, v15
    v_cvt_pk_bf16_f32 v0, v0, v1
    v_cvt_pk_bf16_f32 v1, v2, v3
    v_cvt_pk_bf16_f32 v2, v4, v5
    v_cvt_pk_bf16_f32 v3, v6, v7
    v_cvt_pk_bf16_f32 v8, v8, v9
    v_cvt_pk_bf16_f32 v9, v10, v11
    v_cvt_pk_bf16_f32 v10, v12, v13
    v_cvt_pk_bf16_f32 v11, v14, v15
    ds_write_b128 v209, v[0:3] offset:0
    ds_write_b128 v209, v[8:11] offset:1024
    v_mul_f32 v16, s6, v16
    v_mul_f32 v17, s6, v17
    v_mul_f32 v18, s6, v18
    v_mul_f32 v19, s6, v19
    v_mul_f32 v20, s6, v20
    v_mul_f32 v21, s6, v21
    v_mul_f32 v22, s6, v22
    v_mul_f32 v23, s6, v23
    v_mul_f32 v24, s6, v24
    v_mul_f32 v25, s6, v25
    v_mul_f32 v26, s6, v26
    v_mul_f32 v27, s6, v27
    v_mul_f32 v28, s6, v28
    v_mul_f32 v29, s6, v29
    v_mul_f32 v30, s6, v30
    v_mul_f32 v31, s6, v31
    v_cvt_pk_bf16_f32 v16, v16, v17
    v_cvt_pk_bf16_f32 v17, v18, v19
    v_cvt_pk_bf16_f32 v18, v20, v21
    v_cvt_pk_bf16_f32 v19, v22, v23
    v_cvt_pk_bf16_f32 v24, v24, v25
    v_cvt_pk_bf16_f32 v25, v26, v27
    v_cvt_pk_bf16_f32 v26, v28, v29
    v_cvt_pk_bf16_f32 v27, v30, v31
    ds_write_b128 v209, v[16:19] offset:2048
    ds_write_b128 v209, v[24:27] offset:3072
    v_mul_f32 v32, s6, v32
    v_mul_f32 v33, s6, v33
    v_mul_f32 v34, s6, v34
    v_mul_f32 v35, s6, v35
    v_mul_f32 v36, s6, v36
    v_mul_f32 v37, s6, v37
    v_mul_f32 v38, s6, v38
    v_mul_f32 v39, s6, v39
    v_mul_f32 v40, s6, v40
    v_mul_f32 v41, s6, v41
    v_mul_f32 v42, s6, v42
    v_mul_f32 v43, s6, v43
    v_mul_f32 v44, s6, v44
    v_mul_f32 v45, s6, v45
    v_mul_f32 v46, s6, v46
    v_mul_f32 v47, s6, v47
    v_cvt_pk_bf16_f32 v32, v32, v33
    v_cvt_pk_bf16_f32 v33, v34, v35
    v_cvt_pk_bf16_f32 v34, v36, v37
    v_cvt_pk_bf16_f32 v35, v38, v39
    v_cvt_pk_bf16_f32 v40, v40, v41
    v_cvt_pk_bf16_f32 v41, v42, v43
    v_cvt_pk_bf16_f32 v42, v44, v45
    v_cvt_pk_bf16_f32 v43, v46, v47
    ds_write_b128 v209, v[32:35] offset:4096
    ds_write_b128 v209, v[40:43] offset:5120
    v_mul_f32 v48, s6, v48
    v_mul_f32 v49, s6, v49
    v_mul_f32 v50, s6, v50
    v_mul_f32 v51, s6, v51
    v_mul_f32 v52, s6, v52
    v_mul_f32 v53, s6, v53
    v_mul_f32 v54, s6, v54
    v_mul_f32 v55, s6, v55
    v_mul_f32 v56, s6, v56
    v_mul_f32 v57, s6, v57
    v_mul_f32 v58, s6, v58
    v_mul_f32 v59, s6, v59
    v_mul_f32 v60, s6, v60
    v_mul_f32 v61, s6, v61
    v_mul_f32 v62, s6, v62
    v_mul_f32 v63, s6, v63
    v_cvt_pk_bf16_f32 v48, v48, v49
    v_cvt_pk_bf16_f32 v49, v50, v51
    v_cvt_pk_bf16_f32 v50, v52, v53
    v_cvt_pk_bf16_f32 v51, v54, v55
    v_cvt_pk_bf16_f32 v56, v56, v57
    v_cvt_pk_bf16_f32 v57, v58, v59
    v_cvt_pk_bf16_f32 v58, v60, v61
    v_cvt_pk_bf16_f32 v59, v62, v63
    ds_write_b128 v209, v[48:51] offset:6144
    ds_write_b128 v209, v[56:59] offset:7168
    s_waitcnt vmcnt(0)
    s_mov_b32 s30, 1
    s_mov_b32 s51, 32768
    s_mov_b32 s32, 65536
    s_mov_b32 s43, 32768
    s_mov_b32 s44, 0
    s_mov_b32 s40, 131072
    s_mov_b32 s31, 0
    s_mov_b32 s33, 0
    s_mul_i32 s3, s26, 65536
    s_add_u32 s3, s3, s49
    s_add_u32 s42, s3, 16384
    s_and_b32 s42, s42, 0x1ffff
    s_add_u32 s41, s3, 49152
    s_and_b32 s41, s41, 0x1ffff
    s_mov_b32 s46, 0xff800000
    s_mov_b32 s47, 0
    s_lshl_b32 s3, s26, 17
    s_add_u32 s12, s12, s3
    s_addc_u32 s13, s13, 0
    s_add_u32 s16, s16, s3
    s_addc_u32 s17, s17, 0
    s_mov_b32 s14, 131072
    s_mov_b32 s18, 131072
    s_waitcnt lgkmcnt(0)
    s_barrier
    v_mov_b32 v232, 123392
    ds_read_b32 v232, v232
    ds_read_b128 v[192:195], v208 offset:0
    ds_read_b128 v[196:199], v208 offset:64
    ds_read_b128 v[200:203], v208 offset:128
    ds_read_b128 v[204:207], v208 offset:192
    v_mul_f32 v64, s6, v64
    v_mul_f32 v65, s6, v65
    v_mul_f32 v66, s6, v66
    v_mul_f32 v67, s6, v67
    v_mul_f32 v68, s6, v68
    v_mul_f32 v69, s6, v69
    v_mul_f32 v70, s6, v70
    v_mul_f32 v71, s6, v71
    v_mul_f32 v72, s6, v72
    v_mul_f32 v73, s6, v73
    v_mul_f32 v74, s6, v74
    v_mul_f32 v75, s6, v75
    v_mul_f32 v76, s6, v76
    v_mul_f32 v77, s6, v77
    v_mul_f32 v78, s6, v78
    v_mul_f32 v79, s6, v79
    s_waitcnt lgkmcnt(0)
    s_barrier
    v_readfirstlane_b32 s34, v232
    v_cvt_pk_bf16_f32 v112, v64, v65
    v_cvt_pk_bf16_f32 v113, v66, v67
    v_cvt_pk_bf16_f32 v114, v68, v69
    v_cvt_pk_bf16_f32 v115, v70, v71
    v_cvt_pk_bf16_f32 v116, v72, v73
    v_cvt_pk_bf16_f32 v117, v74, v75
    v_cvt_pk_bf16_f32 v118, v76, v77
    v_cvt_pk_bf16_f32 v119, v78, v79
    v_mul_f32 v80, s6, v80
    v_mul_f32 v81, s6, v81
    v_mul_f32 v82, s6, v82
    v_mul_f32 v83, s6, v83
    v_mul_f32 v84, s6, v84
    v_mul_f32 v85, s6, v85
    v_mul_f32 v86, s6, v86
    v_mul_f32 v87, s6, v87
    v_mul_f32 v88, s6, v88
    v_mul_f32 v89, s6, v89
    v_mul_f32 v90, s6, v90
    v_mul_f32 v91, s6, v91
    v_mul_f32 v92, s6, v92
    v_mul_f32 v93, s6, v93
    v_mul_f32 v94, s6, v94
    v_mul_f32 v95, s6, v95
    v_cvt_pk_bf16_f32 v120, v80, v81
    v_cvt_pk_bf16_f32 v121, v82, v83
    v_cvt_pk_bf16_f32 v122, v84, v85
    v_cvt_pk_bf16_f32 v123, v86, v87
    v_cvt_pk_bf16_f32 v124, v88, v89
    v_cvt_pk_bf16_f32 v125, v90, v91
    v_cvt_pk_bf16_f32 v126, v92, v93
    v_cvt_pk_bf16_f32 v127, v94, v95
    v_mul_f32 v144, s6, v144
    v_mul_f32 v145, s6, v145
    v_mul_f32 v146, s6, v146
    v_mul_f32 v147, s6, v147
    v_mul_f32 v148, s6, v148
    v_mul_f32 v149, s6, v149
    v_mul_f32 v150, s6, v150
    v_mul_f32 v151, s6, v151
    v_mul_f32 v152, s6, v152
    v_mul_f32 v153, s6, v153
    v_mul_f32 v154, s6, v154
    v_mul_f32 v155, s6, v155
    v_mul_f32 v156, s6, v156
    v_mul_f32 v157, s6, v157
    v_mul_f32 v158, s6, v158
    v_mul_f32 v159, s6, v159
    v_cvt_pk_bf16_f32 v128, v144, v145
    v_cvt_pk_bf16_f32 v129, v146, v147
    v_cvt_pk_bf16_f32 v130, v148, v149
    v_cvt_pk_bf16_f32 v131, v150, v151
    v_cvt_pk_bf16_f32 v132, v152, v153
    v_cvt_pk_bf16_f32 v133, v154, v155
    v_cvt_pk_bf16_f32 v134, v156, v157
    v_cvt_pk_bf16_f32 v135, v158, v159
    v_mul_f32 v176, s6, v176
    v_mul_f32 v177, s6, v177
    v_mul_f32 v178, s6, v178
    v_mul_f32 v179, s6, v179
    v_mul_f32 v180, s6, v180
    v_mul_f32 v181, s6, v181
    v_mul_f32 v182, s6, v182
    v_mul_f32 v183, s6, v183
    v_mul_f32 v184, s6, v184
    v_mul_f32 v185, s6, v185
    v_mul_f32 v186, s6, v186
    v_mul_f32 v187, s6, v187
    v_mul_f32 v188, s6, v188
    v_mul_f32 v189, s6, v189
    v_mul_f32 v190, s6, v190
    v_mul_f32 v191, s6, v191
    v_cvt_pk_bf16_f32 v136, v176, v177
    v_cvt_pk_bf16_f32 v137, v178, v179
    v_cvt_pk_bf16_f32 v138, v180, v181
    v_cvt_pk_bf16_f32 v139, v182, v183
    v_cvt_pk_bf16_f32 v140, v184, v185
    v_cvt_pk_bf16_f32 v141, v186, v187
    v_cvt_pk_bf16_f32 v142, v188, v189
    v_cvt_pk_bf16_f32 v143, v190, v191
    v_mov_b32 v0, 0
    v_mov_b32 v1, 0
    v_mov_b32 v2, 0
    v_mov_b32 v3, 0
    v_mov_b32 v4, 0
    v_mov_b32 v5, 0
    v_mov_b32 v6, 0
    v_mov_b32 v7, 0
    v_mov_b32 v8, 0
    v_mov_b32 v9, 0
    v_mov_b32 v10, 0
    v_mov_b32 v11, 0
    v_mov_b32 v12, 0
    v_mov_b32 v13, 0
    v_mov_b32 v14, 0
    v_mov_b32 v15, 0
    v_mov_b32 v16, 0
    v_mov_b32 v17, 0
    v_mov_b32 v18, 0
    v_mov_b32 v19, 0
    v_mov_b32 v20, 0
    v_mov_b32 v21, 0
    v_mov_b32 v22, 0
    v_mov_b32 v23, 0
    v_mov_b32 v24, 0
    v_mov_b32 v25, 0
    v_mov_b32 v26, 0
    v_mov_b32 v27, 0
    v_mov_b32 v28, 0
    v_mov_b32 v29, 0
    v_mov_b32 v30, 0
    v_mov_b32 v31, 0
    v_mov_b32 v32, 0
    v_mov_b32 v33, 0
    v_mov_b32 v34, 0
    v_mov_b32 v35, 0
    v_mov_b32 v36, 0
    v_mov_b32 v37, 0
    v_mov_b32 v38, 0
    v_mov_b32 v39, 0
    v_mov_b32 v40, 0
    v_mov_b32 v41, 0
    v_mov_b32 v42, 0
    v_mov_b32 v43, 0
    v_mov_b32 v44, 0
    v_mov_b32 v45, 0
    v_mov_b32 v46, 0
    v_mov_b32 v47, 0
    v_mov_b32 v48, 0
    v_mov_b32 v49, 0
    v_mov_b32 v50, 0
    v_mov_b32 v51, 0
    v_mov_b32 v52, 0
    v_mov_b32 v53, 0
    v_mov_b32 v54, 0
    v_mov_b32 v55, 0
    v_mov_b32 v56, 0
    v_mov_b32 v57, 0
    v_mov_b32 v58, 0
    v_mov_b32 v59, 0
    v_mov_b32 v60, 0
    v_mov_b32 v61, 0
    v_mov_b32 v62, 0
    v_mov_b32 v63, 0
    v_mov_b32 v96, 0
    v_mov_b32 v97, 0
    v_mov_b32 v98, 0
    v_mov_b32 v99, 0
    v_mov_b32 v100, 0
    v_mov_b32 v101, 0
    v_mov_b32 v102, 0
    v_mov_b32 v103, 0
    v_mov_b32 v104, 0
    v_mov_b32 v105, 0
    v_mov_b32 v106, 0
    v_mov_b32 v107, 0
    v_mov_b32 v160, 0
    v_mov_b32 v161, 0
    v_mov_b32 v162, 0
    v_mov_b32 v163, 0
    v_mov_b32 v164, 0
    v_mov_b32 v165, 0
    v_mov_b32 v166, 0
    v_mov_b32 v167, 0
    v_mov_b32 v168, 0
    v_mov_b32 v169, 0
    v_mov_b32 v170, 0
    v_mov_b32 v171, 0
    v_mov_b32 v172, 0
    v_mov_b32 v173, 0
    v_mov_b32 v174, 0
    v_mov_b32 v175, 0
    v_mov_b32 v176, 0
    v_mov_b32 v177, 0
    v_mov_b32 v178, 0
    v_mov_b32 v179, 0
    v_mov_b32 v180, 0
    v_mov_b32 v181, 0
    v_mov_b32 v182, 0
    v_mov_b32 v183, 0
    v_mov_b32 v184, 0
    v_mov_b32 v185, 0
    v_mov_b32 v186, 0
    v_mov_b32 v187, 0
    v_mov_b32 v188, 0
    v_mov_b32 v189, 0
    v_mov_b32 v190, 0
    v_mov_b32 v191, 0
K1_HEAD:
    ds_read_b128 v[236:239], v222 offset:0
    ds_read_b128 v[240:243], v222 offset:2048
    v_xor_b32 v231, 32, v222
    ds_read_b128 v[244:247], v231 offset:0
    ds_read_b128 v[248:251], v231 offset:2048
    ds_read_b128 v[252:255], v223
    s_waitcnt lgkmcnt(3)
    v_mfma_f32_32x32x16_bf16 v[64:79], v[236:239], v[112:115], v[96:111]
    v_xor_b32 v230, 64, v222
    ds_read_b128 v[236:239], v230 offset:0
    v_mfma_f32_32x32x16_bf16 v[80:95], v[240:243], v[112:115], v[96:111]
    ds_read_b128 v[240:243], v230 offset:2048
    s_add_u32 m0, s40, s50
    s_nop 0
    buffer_load_dwordx4 v221, s[16:19], s42 offen offset:0 nt lds
    s_waitcnt lgkmcnt(3)
    v_mfma_f32_32x32x16_bf16 v[64:79], v[244:247], v[116:119], v[64:79]
    v_xor_b32 v234, 64, v223
    ds_read_b128 v[244:247], v234
    v_mfma_f32_32x32x16_bf16 v[80:95], v[248:251], v[116:119], v[80:95]
    v_xor_b32 v231, 96, v222
    ds_read_b128 v[248:251], v231 offset:0
    buffer_load_dwordx4 v221, s[16:19], s42 offen offset:1024 nt lds
    s_waitcnt lgkmcnt(3)
    v_mfma_f32_16x16x32_bf16 v[208:211], v[252:255], v[192:195], v[212:215]
    ds_read_b128 v[252:255], v231 offset:2048
    v_mfma_f32_32x32x16_bf16 v[64:79], v[236:239], v[120:123], v[64:79]
    v_xor_b32 v234, 128, v223
    ds_read_b128 v[236:239], v234
    buffer_load_dwordx4 v221, s[16:19], s42 offen offset:2048 nt lds
    s_waitcnt lgkmcnt(3)
    v_mfma_f32_32x32x16_bf16 v[80:95], v[240:243], v[120:123], v[80:95]
    v_xor_b32 v230, 128, v222
    ds_read_b128 v[240:243], v230 offset:0
    v_mfma_f32_16x16x32_bf16 v[208:211], v[244:247], v[196:199], v[208:211]
    ds_read_b128 v[244:247], v230 offset:2048
    buffer_load_dwordx4 v221, s[16:19], s42 offen offset:3072 nt lds
    s_add_u32 s42, s42, 16384
    s_and_b32 s42, s42, 0x1ffff
    s_waitcnt lgkmcnt(3)
    v_mfma_f32_32x32x16_bf16 v[64:79], v[248:251], v[124:127], v[64:79]
    v_xor_b32 v234, 192, v223
    ds_read_b128 v[248:251], v234
    v_mfma_f32_32x32x16_bf16 v[80:95], v[252:255], v[124:127], v[80:95]
    v_xor_b32 v231, 160, v222
    ds_read_b128 v[252:255], v231 offset:0
    s_waitcnt lgkmcnt(3)
    v_mfma_f32_16x16x32_bf16 v[208:211], v[236:239], v[200:203], v[208:211]
    ds_read_b128 v[236:239], v231 offset:2048
    v_mfma_f32_32x32x16_bf16 v[64:79], v[240:243], v[128:131], v[64:79]
    v_xor_b32 v230, 192, v222
    ds_read_b128 v[240:243], v230 offset:0
    s_waitcnt lgkmcnt(3)
    v_mfma_f32_32x32x16_bf16 v[80:95], v[244:247], v[128:131], v[80:95]
    ds_read_b128 v[244:247], v230 offset:2048
    v_mfma_f32_16x16x32_bf16 v[208:211], v[248:251], v[204:207], v[208:211]
    v_xor_b32 v231, 224, v222
    ds_read_b128 v[248:251], v231 offset:0
    s_waitcnt lgkmcnt(3)
    v_mfma_f32_32x32x16_bf16 v[64:79], v[252:255], v[132:135], v[64:79]
    ds_read_b128 v[252:255], v231 offset:2048
    v_mfma_f32_32x32x16_bf16 v[80:95], v[236:239], v[132:135], v[80:95]
    s_cmp_lt_u32 s24, 4
    s_cbranch_scc1 K1_Y0
    s_waitcnt vmcnt(63)
    s_waitcnt lgkmcnt(0)
    s_barrier
K1_Y0:
    s_waitcnt lgkmcnt(2)
    v_mfma_f32_32x32x16_bf16 v[64:79], v[240:243], v[136:139], v[64:79]
    v_mfma_f32_32x32x16_bf16 v[80:95], v[244:247], v[136:139], v[80:95]
    s_waitcnt lgkmcnt(0)
    v_mfma_f32_32x32x16_bf16 v[64:79], v[248:251], v[140:143], v[64:79]
    v_mfma_f32_32x32x16_bf16 v[80:95], v[252:255], v[140:143], v[80:95]
    s_mov_b32 s40, 0x30000
    s_sub_u32 s42, s42, 16384
    s_and_b32 s42, s42, 0x1ffff
    s_setprio 0
    v_add_u32 v222, s43, v222
    v_add_u32 v223, s43, v223
    v_max3_f32 v231, v208, v209, v210
    v_max_f32 v231, v231, v211
    s_nop 2
    v_max3_f32 v230, v64, v65, v66
    v_max3_f32 v230, v230, v67, v68
    v_max3_f32 v230, v230, v69, v70
    v_max3_f32 v230, v230, v71, v72
    v_max3_f32 v230, v230, v73, v74
    v_max3_f32 v230, v230, v75, v76
    v_max3_f32 v230, v230, v77, v78
    v_max3_f32 v234, v80, v81, v82
    v_max3_f32 v234, v234, v83, v84
    v_max3_f32 v234, v234, v85, v86
    v_max3_f32 v234, v234, v87, v88
    v_max3_f32 v234, v234, v89, v90
    v_max3_f32 v234, v234, v91, v92
    v_max3_f32 v234, v234, v93, v94
    v_max3_f32 v234, v234, v79, v95
    v_max_f32 v230, v230, v234
    v_max_f32 v234, v230, v231
    s_branch K1_RARE1
K1_CPB:
    s_mov_b32 s47, 0
    v_exp_f32 v64, v64
    v_exp_f32 v65, v65
    v_exp_f32 v66, v66
    v_exp_f32 v67, v67
    v_add_f32 v218, v218, v64
    v_add_f32 v218, v218, v65
    v_exp_f32 v68, v68
    v_exp_f32 v69, v69
    v_add_f32 v218, v218, v66
    v_add_f32 v218, v218, v67
    v_exp_f32 v70, v70
    v_exp_f32 v71, v71
    v_add_f32 v218, v218, v68
    v_add_f32 v218, v218, v69
    v_exp_f32 v208, v208
    v_exp_f32 v209, v209
    v_exp_f32 v210, v210
    v_exp_f32 v211, v211
    v_add_f32 v218, v218, v70
    v_add_f32 v218, v218, v71
    v_add_f32 v219, v219, v208
    v_add_f32 v219, v219, v209
    v_add_f32 v219, v219, v210
    v_add_f32 v219, v219, v211
    v_cvt_pk_bf16_f32 v144, v64, v65
    v_cvt_pk_bf16_f32 v145, v66, v67
    v_cvt_pk_bf16_f32 v146, v68, v69
    v_cvt_pk_bf16_f32 v147, v70, v71
    v_cvt_pk_bf16_f32 v216, v208, v209
    v_cvt_pk_bf16_f32 v217, v210, v211
    v_exp_f32 v72, v72
    v_exp_f32 v73, v73
    v_exp_f32 v74, v74
    v_exp_f32 v75, v75
    v_add_f32 v218, v218, v72
    v_add_f32 v218, v218, v73
    v_exp_f32 v76, v76
    v_exp_f32 v77, v77
    v_add_f32 v218, v218, v74
    v_add_f32 v218, v218, v75
    v_exp_f32 v78, v78
    v_exp_f32 v79, v79
    v_add_f32 v218, v218, v76
    v_add_f32 v218, v218, v77
    v_add_f32 v218, v218, v78
    v_add_f32 v218, v218, v79
    v_cvt_pk_bf16_f32 v148, v72, v73
    v_cvt_pk_bf16_f32 v149, v74, v75
    v_cvt_pk_bf16_f32 v150, v76, v77
    v_cvt_pk_bf16_f32 v151, v78, v79
    v_exp_f32 v80, v80
    v_exp_f32 v81, v81
    v_exp_f32 v82, v82
    v_exp_f32 v83, v83
    v_add_f32 v218, v218, v80
    v_add_f32 v218, v218, v81
    v_exp_f32 v84, v84
    v_exp_f32 v85, v85
    v_add_f32 v218, v218, v82
    v_add_f32 v218, v218, v83
    v_exp_f32 v86, v86
    v_exp_f32 v87, v87
    v_add_f32 v218, v218, v84
    v_add_f32 v218, v218, v85
    v_add_f32 v218, v218, v86
    v_add_f32 v218, v218, v87
    v_cvt_pk_bf16_f32 v152, v80, v81
    v_cvt_pk_bf16_f32 v153, v82, v83
    v_cvt_pk_bf16_f32 v154, v84, v85
    v_cvt_pk_bf16_f32 v155, v86, v87
    v_exp_f32 v88, v88
    v_exp_f32 v89, v89
    v_exp_f32 v90, v90
    v_exp_f32 v91, v91
    v_add_f32 v218, v218, v88
    v_add_f32 v218, v218, v89
    v_exp_f32 v92, v92
    v_exp_f32 v93, v93
    v_add_f32 v218, v218, v90
    s_cmp_lt_u32 s24, 4
    s_cbranch_scc0 K1_X1
    s_waitcnt vmcnt(12)
    s_waitcnt lgkmcnt(0)
    s_barrier
K1_X1:
    s_waitcnt lgkmcnt(4)
    ds_read_b128 v[236:239], v222 offset:0
    s_waitcnt lgkmcnt(3)
    ds_read_b128 v[240:243], v222 offset:2048
    v_xor_b32 v231, 32, v222
    s_waitcnt lgkmcnt(2)
    ds_read_b128 v[244:247], v231 offset:0
    ds_read_b128 v[248:251], v231 offset:2048
    ds_read_b128 v[252:255], v223
    v_add_f32 v218, v218, v91
    v_exp_f32 v94, v94
    v_exp_f32 v95, v95
    v_add_f32 v218, v218, v92
    v_add_f32 v218, v218, v93
    v_add_f32 v218, v218, v94
    v_add_f32 v218, v218, v95
    v_cvt_pk_bf16_f32 v156, v88, v89
    v_cvt_pk_bf16_f32 v157, v90, v91
    v_cvt_pk_bf16_f32 v158, v92, v93
    v_cvt_pk_bf16_f32 v159, v94, v95
K1_TOP:
    s_setprio 1
    s_waitcnt lgkmcnt(3)
    v_mfma_f32_32x32x16_bf16 v[64:79], v[236:239], v[112:115], v[96:111]
    v_xor_b32 v230, 64, v222
    ds_read_b128 v[236:239], v230 offset:0
    s_add_u32 m0, s40, s50
    s_nop 0
    buffer_load_dwordx4 v221, s[16:19], s42 offen offset:0 nt lds
    v_mfma_f32_32x32x16_bf16 v[80:95], v[240:243], v[112:115], v[96:111]
    ds_read_b128 v[240:243], v230 offset:2048
    s_waitcnt lgkmcnt(3)
    v_mfma_f32_32x32x16_bf16 v[64:79], v[244:247], v[116:119], v[64:79]
    v_xor_b32 v234, 64, v223
    ds_read_b128 v[244:247], v234
    v_add_u32 v226, s44, v226
    v_add_u32 v227, s44, v227
    v_add_u32 v228, s44, v228
    v_add_u32 v229, s44, v229
    v_add_u32 v224, s44, v224
    v_mfma_f32_32x32x16_bf16 v[80:95], v[248:251], v[116:119], v[80:95]
    v_xor_b32 v231, 96, v222
    ds_read_b128 v[248:251], v231 offset:0
    s_waitcnt lgkmcnt(3)
    v_mfma_f32_16x16x32_bf16 v[208:211], v[252:255], v[192:195], v[212:215]
    ds_read_b128 v[252:255], v231 offset:2048
    buffer_load_dwordx4 v221, s[16:19], s42 offen offset:1024 nt lds
    v_mfma_f32_32x32x16_bf16 v[64:79], v[236:239], v[120:123], v[64:79]
    v_xor_b32 v234, 128, v223
    ds_read_b128 v[236:239], v234
    s_waitcnt lgkmcnt(3)
    v_mfma_f32_32x32x16_bf16 v[80:95], v[240:243], v[120:123], v[80:95]
    v_xor_b32 v230, 128, v222
    ds_read_b128 v[240:243], v230 offset:0
    v_mfma_f32_16x16x32_bf16 v[208:211], v[244:247], v[196:199], v[208:211]
    ds_read_b128 v[244:247], v230 offset:2048
    s_waitcnt lgkmcnt(3)
    v_mfma_f32_32x32x16_bf16 v[64:79], v[248:251], v[124:127], v[64:79]
    v_xor_b32 v234, 192, v223
    ds_read_b128 v[248:251], v234
    buffer_load_dwordx4 v221, s[16:19], s42 offen offset:2048 nt lds
    v_mfma_f32_32x32x16_bf16 v[80:95], v[252:255], v[124:127], v[80:95]
    v_xor_b32 v231, 160, v222
    ds_read_b128 v[252:255], v231 offset:0
    s_mov_b32 s40, s51
    s_add_u32 s51, s51, 65536
    s_cmp_ge_u32 s51, 163840
    s_cselect_b32 s3, 163840, 0
    s_sub_u32 s51, s51, s3
    s_sub_u32 s43, 65536, s3
    s_nop 0
    s_waitcnt lgkmcnt(3)
    v_mfma_f32_16x16x32_bf16 v[208:211], v[236:239], v[200:203], v[208:211]
    ds_read_b128 v[236:239], v231 offset:2048
    v_mfma_f32_32x32x16_bf16 v[64:79], v[240:243], v[128:131], v[64:79]
    v_xor_b32 v230, 192, v222
    ds_read_b128 v[240:243], v230 offset:0
    s_cmp_lt_u32 s30, 6
    s_cselect_b32 s31, s33, 0x30000
    s_mov_b32 s33, s32
    s_add_u32 s32, s32, 65536
    s_cmp_ge_u32 s32, 163840
    s_cselect_b32 s3, 163840, 0
    s_sub_u32 s32, s32, s3
    s_sub_u32 s44, 65536, s3
    s_waitcnt lgkmcnt(3)
    v_mfma_f32_32x32x16_bf16 v[80:95], v[244:247], v[128:131], v[80:95]
    ds_read_b128 v[244:247], v230 offset:2048
    buffer_load_dwordx4 v221, s[16:19], s42 offen offset:3072 nt lds
    s_add_u32 s42, s42, 16384
    s_and_b32 s42, s42, 0x1ffff
    v_mfma_f32_16x16x32_bf16 v[208:211], v[248:251], v[204:207], v[208:211]
    v_xor_b32 v231, 224, v222
    ds_read_b128 v[248:251], v231 offset:0
    s_waitcnt lgkmcnt(3)
    v_mfma_f32_32x32x16_bf16 v[64:79], v[252:255], v[132:135], v[64:79]
    ds_read_b128 v[252:255], v231 offset:2048
    v_mfma_f32_32x32x16_bf16 v[80:95], v[236:239], v[132:135], v[80:95]
    s_cmp_lt_u32 s24, 4
    s_cbranch_scc1 K1_Y
    s_waitcnt vmcnt(4)
    s_waitcnt lgkmcnt(0)
    s_barrier
K1_Y:
    ds_read_b64_tr_b16 v[236:237], v226 offset:0
    ds_read_b64_tr_b16 v[238:239], v226 offset:4096
    s_waitcnt lgkmcnt(4)
    v_mfma_f32_32x32x16_bf16 v[64:79], v[240:243], v[136:139], v[64:79]
    ds_read_b64_tr_b16 v[240:241], v224 offset:0
    ds_read_b64_tr_b16 v[242:243], v224 offset:32
    v_mfma_f32_32x32x16_bf16 v[80:95], v[244:247], v[136:139], v[80:95]
    ds_read_b64_tr_b16 v[244:245], v227 offset:0
    ds_read_b64_tr_b16 v[246:247], v227 offset:4096
    s_waitcnt lgkmcnt(6)
    v_mfma_f32_32x32x16_bf16 v[64:79], v[248:251], v[140:143], v[64:79]
    v_xor_b32 v235, 64, v224
    ds_read_b64_tr_b16 v[248:249], v235 offset:0
    ds_read_b64_tr_b16 v[250:251], v235 offset:32
    v_mfma_f32_32x32x16_bf16 v[80:95], v[252:255], v[140:143], v[80:95]
    ds_read_b64_tr_b16 v[252:253], v228 offset:0
    ds_read_b64_tr_b16 v[254:255], v228 offset:4096
    s_setprio 0
    s_waitcnt lgkmcnt(6)
    v_mfma_f32_32x32x16_bf16 v[0:15], v[236:239], v[144:147], v[0:15]
    v_xor_b32 v235, 128, v224
    ds_read_b64_tr_b16 v[236:237], v235 offset:0
    ds_read_b64_tr_b16 v[238:239], v235 offset:32
    s_add_u32 m0, s31, s50
    s_nop 0
    buffer_load_dwordx4 v220, s[12:15], s41 offen offset:0 nt lds
    v_add_u32 v222, s43, v222
    v_add_u32 v223, s43, v223
    v_max3_f32 v231, v208, v209, v210
    v_max_f32 v231, v231, v211
    v_max3_f32 v230, v64, v65, v66
    v_max3_f32 v230, v230, v67, v68
    v_max3_f32 v230, v230, v69, v70
    v_max3_f32 v230, v230, v71, v72
    v_mfma_f32_16x16x16_bf16 v[160:163], v[240:241], v[216:217], v[160:163]
    v_mfma_f32_16x16x16_bf16 v[164:167], v[242:243], v[216:217], v[164:167]
    ds_read_b64_tr_b16 v[240:241], v229 offset:0
    ds_read_b64_tr_b16 v[242:243], v229 offset:4096
    v_max3_f32 v230, v230, v73, v74
    v_max3_f32 v230, v230, v75, v76
    v_max3_f32 v230, v230, v77, v78
    v_max3_f32 v234, v80, v81, v82
    v_max3_f32 v234, v234, v83, v84
    v_max3_f32 v234, v234, v85, v86
    v_max3_f32 v234, v234, v87, v88
    v_max3_f32 v234, v234, v89, v90
    s_waitcnt lgkmcnt(6)
    v_mfma_f32_32x32x16_bf16 v[16:31], v[244:247], v[144:147], v[16:31]
    v_xor_b32 v235, 192, v224
    ds_read_b64_tr_b16 v[244:245], v235 offset:0
    ds_read_b64_tr_b16 v[246:247], v235 offset:32
    v_max3_f32 v234, v234, v91, v92
    v_max3_f32 v234, v234, v93, v94
    v_max3_f32 v234, v234, v79, v95
    v_max_f32 v230, v230, v234
    v_max_f32 v234, v230, v231
    v_cmp_lt_f32 vcc, s45, v234
    s_cbranch_vccnz K1_RARE1
K1_R1B:
    v_exp_f32 v64, v64
    v_mfma_f32_16x16x16_bf16 v[168:171], v[248:249], v[216:217], v[168:171]
    v_mfma_f32_16x16x16_bf16 v[172:175], v[250:251], v[216:217], v[172:175]
    ds_read_b64_tr_b16 v[248:249], v226 offset:8192
    ds_read_b64_tr_b16 v[250:251], v226 offset:12288
    v_exp_f32 v65, v65
    v_exp_f32 v66, v66
    v_exp_f32 v67, v67
    v_add_f32 v218, v218, v64
    v_add_f32 v218, v218, v65
    s_waitcnt lgkmcnt(6)
    v_mfma_f32_32x32x16_bf16 v[32:47], v[252:255], v[144:147], v[32:47]
    ds_read_b64_tr_b16 v[252:253], v227 offset:8192
    ds_read_b64_tr_b16 v[254:255], v227 offset:12288
    buffer_load_dwordx4 v220, s[12:15], s41 offen offset:1024 nt lds
    v_exp_f32 v68, v68
    v_exp_f32 v69, v69
    v_add_f32 v218, v218, v66
    v_add_f32 v218, v218, v67
    v_mfma_f32_16x16x16_bf16 v[176:179], v[236:237], v[216:217], v[176:179]
    v_mfma_f32_16x16x16_bf16 v[180:183], v[238:239], v[216:217], v[180:183]
    ds_read_b64_tr_b16 v[236:237], v228 offset:8192
    ds_read_b64_tr_b16 v[238:239], v228 offset:12288
    v_exp_f32 v70, v70
    v_exp_f32 v71, v71
    v_add_f32 v218, v218, v68
    v_add_f32 v218, v218, v69
    v_exp_f32 v208, v208
    s_waitcnt lgkmcnt(6)
    v_mfma_f32_32x32x16_bf16 v[48:63], v[240:243], v[144:147], v[48:63]
    ds_read_b64_tr_b16 v[240:241], v229 offset:8192
    ds_read_b64_tr_b16 v[242:243], v229 offset:12288
    v_exp_f32 v209, v209
    v_exp_f32 v210, v210
    v_exp_f32 v211, v211
    v_add_f32 v218, v218, v70
    v_add_f32 v218, v218, v71
    v_add_f32 v219, v219, v208
    v_mfma_f32_16x16x16_bf16 v[184:187], v[244:245], v[216:217], v[184:187]
    v_mfma_f32_16x16x16_bf16 v[188:191], v[246:247], v[216:217], v[188:191]
    ds_read_b64_tr_b16 v[244:245], v226 offset:2048
    ds_read_b64_tr_b16 v[246:247], v226 offset:6144
    v_add_f32 v219, v219, v209
    v_add_f32 v219, v219, v210
    v_add_f32 v219, v219, v211
    v_cvt_pk_bf16_f32 v144, v64, v65
    v_cvt_pk_bf16_f32 v145, v66, v67
    v_cvt_pk_bf16_f32 v146, v68, v69
    v_cvt_pk_bf16_f32 v147, v70, v71
    v_cvt_pk_bf16_f32 v216, v208, v209
    s_waitcnt lgkmcnt(6)
    v_mfma_f32_32x32x16_bf16 v[0:15], v[248:251], v[148:151], v[0:15]
    ds_read_b64_tr_b16 v[248:249], v227 offset:2048
    ds_read_b64_tr_b16 v[250:251], v227 offset:6144
    buffer_load_dwordx4 v220, s[12:15], s41 offen offset:2048 nt lds
    v_cvt_pk_bf16_f32 v217, v210, v211
    v_exp_f32 v72, v72
    v_exp_f32 v73, v73
    v_exp_f32 v74, v74
    v_mfma_f32_32x32x16_bf16 v[16:31], v[252:255], v[148:151], v[16:31]
    ds_read_b64_tr_b16 v[252:253], v228 offset:2048
    ds_read_b64_tr_b16 v[254:255], v228 offset:6144
    v_exp_f32 v75, v75
    v_add_f32 v218, v218, v72
    v_add_f32 v218, v218, v73
    v_exp_f32 v76, v76
    v_exp_f32 v77, v77
    s_waitcnt lgkmcnt(6)
    v_mfma_f32_32x32x16_bf16 v[32:47], v[236:239], v[148:151], v[32:47]
    ds_read_b64_tr_b16 v[236:237], v229 offset:2048
    ds_read_b64_tr_b16 v[238:239], v229 offset:6144
    v_add_f32 v218, v218, v74
    v_add_f32 v218, v218, v75
    v_exp_f32 v78, v78
    v_exp_f32 v79, v79
    v_add_f32 v218, v218, v76
    v_add_f32 v218, v218, v77
    v_mfma_f32_32x32x16_bf16 v[48:63], v[240:243], v[148:151], v[48:63]
    ds_read_b64_tr_b16 v[240:241], v226 offset:10240
    ds_read_b64_tr_b16 v[242:243], v226 offset:14336
    v_add_f32 v218, v218, v78
    v_add_f32 v218, v218, v79
    v_cvt_pk_bf16_f32 v148, v72, v73
    v_cvt_pk_bf16_f32 v149, v74, v75
    v_cvt_pk_bf16_f32 v150, v76, v77
    v_cvt_pk_bf16_f32 v151, v78, v79
    v_exp_f32 v80, v80
    s_waitcnt lgkmcnt(6)
    v_mfma_f32_32x32x16_bf16 v[0:15], v[244:247], v[152:155], v[0:15]
    ds_read_b64_tr_b16 v[244:245], v227 offset:10240
    ds_read_b64_tr_b16 v[246:247], v227 offset:14336
    buffer_load_dwordx4 v220, s[12:15], s41 offen offset:3072 nt lds
    s_add_u32 s41, s41, 16384
    s_and_b32 s41, s41, 0x1ffff
    v_exp_f32 v81, v81
    v_exp_f32 v82, v82
    v_exp_f32 v83, v83
    v_add_f32 v218, v218, v80
    v_add_f32 v218, v218, v81
    v_mfma_f32_32x32x16_bf16 v[16:31], v[248:251], v[152:155], v[16:31]
    ds_read_b64_tr_b16 v[248:249], v228 offset:10240
    ds_read_b64_tr_b16 v[250:251], v228 offset:14336
    v_exp_f32 v84, v84
    v_exp_f32 v85, v85
    v_add_f32 v218, v218, v82
    v_add_f32 v218, v218, v83
    v_exp_f32 v86, v86
    s_waitcnt lgkmcnt(6)
    v_mfma_f32_32x32x16_bf16 v[32:47], v[252:255], v[152:155], v[32:47]
    ds_read_b64_tr_b16 v[252:253], v229 offset:10240
    ds_read_b64_tr_b16 v[254:255], v229 offset:14336
    v_exp_f32 v87, v87
    v_add_f32 v218, v218, v84
    v_add_f32 v218, v218, v85
    v_add_f32 v218, v218, v86
    v_add_f32 v218, v218, v87
    v_mfma_f32_32x32x16_bf16 v[48:63], v[236:239], v[152:155], v[48:63]
    s_cmp_lt_u32 s24, 4
    s_cbranch_scc0 K1_X
    s_waitcnt vmcnt(4)
    s_waitcnt lgkmcnt(0)
    s_barrier
K1_X:
    ds_read_b128 v[236:239], v222 offset:0
    v_cvt_pk_bf16_f32 v152, v80, v81
    v_cvt_pk_bf16_f32 v153, v82, v83
    v_cvt_pk_bf16_f32 v154, v84, v85
    v_cvt_pk_bf16_f32 v155, v86, v87
    v_exp_f32 v88, v88
    v_exp_f32 v89, v89
    s_waitcnt lgkmcnt(5)
    v_mfma_f32_32x32x16_bf16 v[0:15], v[240:243], v[156:159], v[0:15]
    ds_read_b128 v[240:243], v222 offset:2048
    v_exp_f32 v90, v90
    v_exp_f32 v91, v91
    v_add_f32 v218, v218, v88
    v_add_f32 v218, v218, v89
    v_exp_f32 v92, v92
    v_mfma_f32_32x32x16_bf16 v[16:31], v[244:247], v[156:159], v[16:31]
    v_xor_b32 v231, 32, v222
    ds_read_b128 v[244:247], v231 offset:0
    v_exp_f32 v93, v93
    v_add_f32 v218, v218, v90
    v_add_f32 v218, v218, v91
    v_exp_f32 v94, v94
    v_exp_f32 v95, v95
    v_add_f32 v218, v218, v92
    s_waitcnt lgkmcnt(3)
    v_mfma_f32_32x32x16_bf16 v[32:47], v[248:251], v[156:159], v[32:47]
    ds_read_b128 v[248:251], v231 offset:2048
    v_add_f32 v218, v218, v93
    v_add_f32 v218, v218, v94
    v_add_f32 v218, v218, v95
    v_mfma_f32_32x32x16_bf16 v[48:63], v[252:255], v[156:159], v[48:63]
    ds_read_b128 v[252:255], v223
    v_cvt_pk_bf16_f32 v156, v88, v89
    v_cvt_pk_bf16_f32 v157, v90, v91
    v_cvt_pk_bf16_f32 v158, v92, v93
    v_cvt_pk_bf16_f32 v159, v94, v95
    s_add_u32 s30, s30, 1
    s_add_u32 s3, s30, s47
    s_cmp_lt_u32 s3, 8
    s_cbranch_scc1 K1_TOP
    s_cmp_lg_u32 s47, 0
    s_cbranch_scc1 K1_RARE2
K1_NEXT:
    s_cmp_lt_u32 s30, 8
    s_cbranch_scc1 K1_TOP
    s_branch K1_PVO
K1_RARE1:
    v_mov_b32 v234, v230
    v_mov_b32 v235, v231
    s_nop 0
    v_permlane32_swap_b32 v230, v234
    v_permlane32_swap_b32 v231, v235
    v_max3_f32 v230, v230, v234, s46
    v_max_f32 v231, v231, v235
    v_mov_b32 v235, v231
    v_max_f32 v232, 0, v230
    s_nop 0
    v_permlane16_swap_b32 v231, v235
    v_max3_f32 v231, v231, v235, s46
    v_max_f32 v233, 0, v231
    v_exp_f32 v232, -v232
    v_exp_f32 v233, -v233
    v_sub_f32 v64, v64, v230
    v_sub_f32 v65, v65, v230
    v_sub_f32 v66, v66, v230
    v_sub_f32 v67, v67, v230
    v_sub_f32 v68, v68, v230
    v_sub_f32 v69, v69, v230
    v_sub_f32 v70, v70, v230
    v_sub_f32 v71, v71, v230
    v_sub_f32 v72, v72, v230
    v_sub_f32 v73, v73, v230
    v_sub_f32 v74, v74, v230
    v_sub_f32 v75, v75, v230
    v_sub_f32 v76, v76, v230
    v_sub_f32 v77, v77, v230
    v_sub_f32 v78, v78, v230
    v_sub_f32 v79, v79, v230
    v_sub_f32 v80, v80, v230
    v_sub_f32 v81, v81, v230
    v_sub_f32 v82, v82, v230
    v_sub_f32 v83, v83, v230
    v_sub_f32 v84, v84, v230
    v_sub_f32 v85, v85, v230
    v_sub_f32 v86, v86, v230
    v_sub_f32 v87, v87, v230
    v_sub_f32 v88, v88, v230
    v_sub_f32 v89, v89, v230
    v_sub_f32 v90, v90, v230
    v_sub_f32 v91, v91, v230
    v_sub_f32 v92, v92, v230
    v_sub_f32 v93, v93, v230
    v_sub_f32 v94, v94, v230
    v_sub_f32 v95, v95, v230
    v_sub_f32 v96, v96, v230
    v_sub_f32 v97, v97, v230
    v_sub_f32 v98, v98, v230
    v_sub_f32 v99, v99, v230
    v_sub_f32 v100, v100, v230
    v_sub_f32 v101, v101, v230
    v_sub_f32 v102, v102, v230
    v_sub_f32 v103, v103, v230
    v_sub_f32 v104, v104, v230
    v_sub_f32 v105, v105, v230
    v_sub_f32 v106, v106, v230
    v_sub_f32 v107, v107, v230
    v_sub_f32 v108, v108, v230
    v_sub_f32 v109, v109, v230
    v_sub_f32 v110, v110, v230
    v_sub_f32 v111, v111, v230
    v_sub_f32 v208, v208, v231
    v_sub_f32 v209, v209, v231
    v_sub_f32 v210, v210, v231
    v_sub_f32 v211, v211, v231
    v_sub_f32 v212, v212, v231
    v_sub_f32 v213, v213, v231
    v_sub_f32 v214, v214, v231
    v_sub_f32 v215, v215, v231
    v_mul_f32 v218, v218, v232
    v_mul_f32 v219, v219, v233
    s_mov_b32 s45, 1090519040
    s_cmp_lg_u32 s46, 0
    s_mov_b32 s46, 0
    s_mov_b32 s47, 8
    s_cbranch_scc1 K1_CPB
    s_branch K1_R1B
K1_RARE2:
    v_mul_f32 v0, v0, v232
    v_mul_f32 v1, v1, v232
    v_mul_f32 v2, v2, v232
    v_mul_f32 v3, v3, v232
    v_mul_f32 v4, v4, v232
    v_mul_f32 v5, v5, v232
    v_mul_f32 v6, v6, v232
    v_mul_f32 v7, v7, v232
    v_mul_f32 v8, v8, v232
    v_mul_f32 v9, v9, v232
    v_mul_f32 v10, v10, v232
    v_mul_f32 v11, v11, v232
    v_mul_f32 v12, v12, v232
    v_mul_f32 v13, v13, v232
    v_mul_f32 v14, v14, v232
    v_mul_f32 v15, v15, v232
    v_mul_f32 v16, v16, v232
    v_mul_f32 v17, v17, v232
    v_mul_f32 v18, v18, v232
    v_mul_f32 v19, v19, v232
    v_mul_f32 v20, v20, v232
    v_mul_f32 v21, v21, v232
    v_mul_f32 v22, v22, v232
    v_mul_f32 v23, v23, v232
    v_mul_f32 v24, v24, v232
    v_mul_f32 v25, v25, v232
    v_mul_f32 v26, v26, v232
    v_mul_f32 v27, v27, v232
    v_mul_f32 v28, v28, v232
    v_mul_f32 v29, v29, v232
    v_mul_f32 v30, v30, v232
    v_mul_f32 v31, v31, v232
    v_mul_f32 v32, v32, v232
    v_mul_f32 v33, v33, v232
    v_mul_f32 v34, v34, v232
    v_mul_f32 v35, v35, v232
    v_mul_f32 v36, v36, v232
    v_mul_f32 v37, v37, v232
    v_mul_f32 v38, v38, v232
    v_mul_f32 v39, v39, v232
    v_mul_f32 v40, v40, v232
    v_mul_f32 v41, v41, v232
    v_mul_f32 v42, v42, v232
    v_mul_f32 v43, v43, v232
    v_mul_f32 v44, v44, v232
    v_mul_f32 v45, v45, v232
    v_mul_f32 v46, v46, v232
    v_mul_f32 v47, v47, v232
    v_mul_f32 v48, v48, v232
    v_mul_f32 v49, v49, v232
    v_mul_f32 v50, v50, v232
    v_mul_f32 v51, v51, v232
    v_mul_f32 v52, v52, v232
    v_mul_f32 v53, v53, v232
    v_mul_f32 v54, v54, v232
    v_mul_f32 v55, v55, v232
    v_mul_f32 v56, v56, v232
    v_mul_f32 v57, v57, v232
    v_mul_f32 v58, v58, v232
    v_mul_f32 v59, v59, v232
    v_mul_f32 v60, v60, v232
    v_mul_f32 v61, v61, v232
    v_mul_f32 v62, v62, v232
    v_mul_f32 v63, v63, v232
    v_mul_f32 v160, v160, v233
    v_mul_f32 v161, v161, v233
    v_mul_f32 v162, v162, v233
    v_mul_f32 v163, v163, v233
    v_mul_f32 v164, v164, v233
    v_mul_f32 v165, v165, v233
    v_mul_f32 v166, v166, v233
    v_mul_f32 v167, v167, v233
    v_mul_f32 v168, v168, v233
    v_mul_f32 v169, v169, v233
    v_mul_f32 v170, v170, v233
    v_mul_f32 v171, v171, v233
    v_mul_f32 v172, v172, v233
    v_mul_f32 v173, v173, v233
    v_mul_f32 v174, v174, v233
    v_mul_f32 v175, v175, v233
    v_mul_f32 v176, v176, v233
    v_mul_f32 v177, v177, v233
    v_mul_f32 v178, v178, v233
    v_mul_f32 v179, v179, v233
    v_mul_f32 v180, v180, v233
    v_mul_f32 v181, v181, v233
    v_mul_f32 v182, v182, v233
    v_mul_f32 v183, v183, v233
    v_mul_f32 v184, v184, v233
    v_mul_f32 v185, v185, v233
    v_mul_f32 v186, v186, v233
    v_mul_f32 v187, v187, v233
    v_mul_f32 v188, v188, v233
    v_mul_f32 v189, v189, v233
    v_mul_f32 v190, v190, v233
    v_mul_f32 v191, v191, v233
    s_mov_b32 s47, 0
    s_branch K1_NEXT
K1_PVO:
    v_add_u32 v226, s44, v226
    v_add_u32 v227, s44, v227
    v_add_u32 v228, s44, v228
    v_add_u32 v229, s44, v229
    v_add_u32 v224, s44, v224
    s_and_b32 s51, s2, 3
    s_and_b32 s6, s2, 3
    s_mul_i32 s6, s6, 1179648
    s_add_u32 s8, s100, s6
    s_addc_u32 s9, s101, 0
    s_sub_u32 s8, s8, 3072
    s_subb_u32 s9, s9, 0
    s_sub_u32 s10, 4721664, s6
    s_mov_b32 s11, 0x20000
    s_lshr_b32 s6, s2, 3
    s_lshl_b32 s6, s6, 3
    s_add_u32 s6, s6, s24
    s_mul_i32 s6, s6, 4608
    s_add_u32 s6, s6, 3072
    v_lshlrev_b32 v112, 6, v225
    buffer_load_dword v113, v112, s[8:11], s6 offen
    s_add_u32 s6, s6, 4096
    s_mov_b64 exec, 0xff
    buffer_load_dword v114, v112, s[8:11], s6 offen
    s_mov_b64 exec, -1
    s_cmp_lt_u32 s24, 4
    s_cbranch_scc1 K1_Y8
    s_waitcnt vmcnt(2)
    s_waitcnt lgkmcnt(0)
    s_barrier
K1_Y8:
    s_cmp_eq_u32 s25, 0
    s_cbranch_scc0 K1_XL
    s_and_b32 s3, s2, 7
    s_lshl_b32 s3, s3, 3
    s_add_u32 s3, s3, s27
    s_lshl_b32 s3, s3, 7
    v_lshlrev_b32 v115, 2, v225
    s_mov_b64 exec, 15
    s_add_u32 s7, s3, 16384
    buffer_load_dword v114, v115, s[52:55], s7 offen nt
    buffer_load_dword v115, v115, s[52:55], s3 offen offset:32 sc1
    s_mov_b64 exec, -1
K1_XL:
    s_waitcnt lgkmcnt(4)
    ds_read_b64_tr_b16 v[236:237], v226 offset:0
    ds_read_b64_tr_b16 v[238:239], v226 offset:4096
    s_waitcnt lgkmcnt(5)
    ds_read_b64_tr_b16 v[240:241], v224 offset:0
    ds_read_b64_tr_b16 v[242:243], v224 offset:32
    s_waitcnt lgkmcnt(6)
    ds_read_b64_tr_b16 v[244:245], v227 offset:0
    ds_read_b64_tr_b16 v[246:247], v227 offset:4096
    v_xor_b32 v235, 64, v224
    s_waitcnt lgkmcnt(7)
    ds_read_b64_tr_b16 v[248:249], v235 offset:0
    ds_read_b64_tr_b16 v[250:251], v235 offset:32
    s_waitcnt lgkmcnt(8)
    ds_read_b64_tr_b16 v[252:253], v228 offset:0
    ds_read_b64_tr_b16 v[254:255], v228 offset:4096
    s_waitcnt lgkmcnt(6)
    v_mfma_f32_32x32x16_bf16 v[0:15], v[236:239], v[144:147], v[0:15]
    v_xor_b32 v235, 128, v224
    ds_read_b64_tr_b16 v[236:237], v235 offset:0
    ds_read_b64_tr_b16 v[238:239], v235 offset:32
    s_lshl_b32 s6, s29, 3
    s_add_u32 s6, s6, s27
    s_mul_i32 s6, s6, 1179648
    s_add_u32 s20, s66, s6
    s_addc_u32 s21, s67, 0
    s_mov_b32 s22, 1179648
    s_mov_b32 s23, 0x20000
    s_lshl_b32 s6, s28, 1
    s_add_u32 s6, s6, s26
    s_lshl_b32 s7, s6, 13
    v_mfma_f32_16x16x16_bf16 v[160:163], v[240:241], v[216:217], v[160:163]
    v_mfma_f32_16x16x16_bf16 v[164:167], v[242:243], v[216:217], v[164:167]
    ds_read_b64_tr_b16 v[240:241], v229 offset:0
    ds_read_b64_tr_b16 v[242:243], v229 offset:4096
    s_lshl_b32 s41, s25, 18
    s_add_u32 s41, s41, s7
    s_add_u32 s42, s41, 4096
    s_lshl_b32 s40, s6, 12
    s_lshl_b32 s7, s25, 10
    s_add_u32 s40, s40, s7
    s_add_u32 s40, s40, 1048576
    v_mov_b32 v230, v218
    v_mov_b32 v231, v219
    v_lshlrev_b32 v220, 4, v225
    s_waitcnt lgkmcnt(6)
    v_mfma_f32_32x32x16_bf16 v[16:31], v[244:247], v[144:147], v[16:31]
    v_xor_b32 v235, 192, v224
    ds_read_b64_tr_b16 v[244:245], v235 offset:0
    ds_read_b64_tr_b16 v[246:247], v235 offset:32
    v_permlane32_swap_b32 v218, v230
    v_permlane32_swap_b32 v219, v231
    v_add_f32 v218, v218, v230
    v_add_f32 v219, v219, v231
    v_mov_b32 v231, v219
    v_rcp_f32 v232, v218
    s_nop 0
    v_permlane16_swap_b32 v219, v231
    v_add_f32 v213, v219, v231
    s_cmp_lt_u32 s24, 4
    s_mov_b32 s45, 65536
    s_cmov_b32 s45, 118784
    s_mov_b32 s46, 155648
    s_cmov_b32 s46, 135168
    v_mfma_f32_16x16x16_bf16 v[168:171], v[248:249], v[216:217], v[168:171]
    v_mfma_f32_16x16x16_bf16 v[172:175], v[250:251], v[216:217], v[172:175]
    ds_read_b64_tr_b16 v[248:249], v226 offset:8192
    ds_read_b64_tr_b16 v[250:251], v226 offset:12288
    s_lshl_b32 s7, s25, 11
    s_add_u32 s6, s45, s7
    v_add_u32 v116, s6, v220
    s_add_u32 s6, s46, s7
    v_add_u32 v117, s6, v220
    v_and_b32 v119, 15, v225
    v_lshlrev_b32 v119, 3, v119
    s_lshl_b32 s7, s24, 7
    s_add_u32 s7, s7, 20480
    v_add_u32 v118, s7, v119
    s_waitcnt lgkmcnt(6)
    v_mfma_f32_32x32x16_bf16 v[32:47], v[252:255], v[144:147], v[32:47]
    ds_read_b64_tr_b16 v[252:253], v227 offset:8192
    ds_read_b64_tr_b16 v[254:255], v227 offset:12288
    s_and_b32 s56, s28, 3
    s_lshl_b32 s58, s29, 3
    s_add_u32 s58, s58, s27
    s_lshl_b32 s58, s58, 2
    s_add_u32 s58, s58, s56
    s_lshl_b32 s63, s56, 2
    s_add_u32 s35, s63, 4
    s_and_b32 s35, s35, 15
    s_and_b32 s3, s2, 7
    s_lshl_b32 s3, s3, 3
    v_mfma_f32_16x16x16_bf16 v[176:179], v[236:237], v[216:217], v[176:179]
    v_mfma_f32_16x16x16_bf16 v[180:183], v[238:239], v[216:217], v[180:183]
    ds_read_b64_tr_b16 v[236:237], v228 offset:8192
    ds_read_b64_tr_b16 v[238:239], v228 offset:12288
    s_add_u32 s3, s3, s27
    s_lshl_b32 s48, s3, 7
    v_lshlrev_b32 v142, 2, v225
    v_lshlrev_b32 v141, 4, v225
    v_mov_b32 v143, s34
    v_mov_b32 v140, v225
    s_mul_i32 s59, s56, 288
    s_and_b32 s59, s59, 0xffc0
    s_mul_i32 s3, s25, 18432
    s_add_u32 s59, s59, s3
    s_waitcnt lgkmcnt(6)
    v_mfma_f32_32x32x16_bf16 v[48:63], v[240:243], v[144:147], v[48:63]
    ds_read_b64_tr_b16 v[240:241], v229 offset:8192
    ds_read_b64_tr_b16 v[242:243], v229 offset:12288
    s_mul_i32 s61, s25, 5120
    s_lshl_b32 s62, s25, 12
    s_add_u32 s62, s62, 81920
    s_lshl_b32 s43, s25, 9
    s_lshl_b32 s57, s51, 15
    s_add_u32 s57, s57, s43
    s_add_u32 s57, s57, 1048576
    s_add_u32 s43, s43, 98304
    s_lshl_b32 s60, s51, 16
    s_lshl_b32 s3, s25, 18
    v_mfma_f32_16x16x16_bf16 v[184:187], v[244:245], v[216:217], v[184:187]
    v_mfma_f32_16x16x16_bf16 v[188:191], v[246:247], v[216:217], v[188:191]
    ds_read_b64_tr_b16 v[244:245], v226 offset:2048
    ds_read_b64_tr_b16 v[246:247], v226 offset:6144
    s_add_u32 s60, s60, s3
    s_lshl_b32 s3, s27, 2
    s_lshl_b32 s33, 1, s3
    s_mov_b32 s36, 0
    s_mov_b32 s31, 0
    s_mov_b32 s3, 52429
    v_add_u32 v131, 0, v225
    v_mul_lo_u32 v132, s3, v131
    v_lshrrev_b32 v132, 20, v132
    v_mul_u32_u24 v133, 20, v132
    s_waitcnt lgkmcnt(6)
    v_mfma_f32_32x32x16_bf16 v[0:15], v[248:251], v[148:151], v[0:15]
    ds_read_b64_tr_b16 v[248:249], v227 offset:2048
    ds_read_b64_tr_b16 v[250:251], v227 offset:6144
    v_sub_u32 v133, v131, v133
    v_bfe_u32 v134, v132, 3, 1
    v_lshlrev_b32 v134, 1, v134
    v_xor_b32 v133, v133, v134
    v_mul_u32_u24 v132, 1152, v132
    v_lshl_add_u32 v132, v133, 4, v132
    v_add_u32 v120, 3072, v132
    v_add_u32 v131, 64, v225
    v_mul_lo_u32 v132, s3, v131
    v_lshrrev_b32 v132, 20, v132
    v_mfma_f32_32x32x16_bf16 v[16:31], v[252:255], v[148:151], v[16:31]
    ds_read_b64_tr_b16 v[252:253], v228 offset:2048
    ds_read_b64_tr_b16 v[254:255], v228 offset:6144
    v_mul_u32_u24 v133, 20, v132
    v_sub_u32 v133, v131, v133
    v_bfe_u32 v134, v132, 3, 1
    v_lshlrev_b32 v134, 1, v134
    v_xor_b32 v133, v133, v134
    v_mul_u32_u24 v132, 1152, v132
    v_lshl_add_u32 v132, v133, 4, v132
    v_add_u32 v121, 2048, v132
    v_add_u32 v131, 128, v225
    v_mul_lo_u32 v132, s3, v131
    s_waitcnt lgkmcnt(6)
    v_mfma_f32_32x32x16_bf16 v[32:47], v[236:239], v[148:151], v[32:47]
    ds_read_b64_tr_b16 v[236:237], v229 offset:2048
    ds_read_b64_tr_b16 v[238:239], v229 offset:6144
    v_lshrrev_b32 v132, 20, v132
    v_mul_u32_u24 v133, 20, v132
    v_sub_u32 v133, v131, v133
    v_bfe_u32 v134, v132, 3, 1
    v_lshlrev_b32 v134, 1, v134
    v_xor_b32 v133, v133, v134
    v_mul_u32_u24 v132, 1152, v132
    v_lshl_add_u32 v132, v133, 4, v132
    v_add_u32 v122, 1024, v132
    v_add_u32 v131, 192, v225
    ds_write_b64 v118, v[212:213]
    v_mfma_f32_32x32x16_bf16 v[48:63], v[240:243], v[148:151], v[48:63]
    ds_read_b64_tr_b16 v[240:241], v226 offset:10240
    ds_read_b64_tr_b16 v[242:243], v226 offset:14336
    v_mul_lo_u32 v132, s3, v131
    v_lshrrev_b32 v132, 20, v132
    v_mul_u32_u24 v133, 20, v132
    v_sub_u32 v133, v131, v133
    v_bfe_u32 v134, v132, 3, 1
    v_lshlrev_b32 v134, 1, v134
    v_xor_b32 v133, v133, v134
    v_mul_u32_u24 v132, 1152, v132
    v_lshl_add_u32 v132, v133, 4, v132
    v_add_u32 v123, 0, v132
    ds_write_b128 v116, v[168:171] offset:0
    s_waitcnt lgkmcnt(8)
    v_mfma_f32_32x32x16_bf16 v[0:15], v[244:247], v[152:155], v[0:15]
    ds_read_b64_tr_b16 v[244:245], v227 offset:10240
    ds_read_b64_tr_b16 v[246:247], v227 offset:14336
    v_add_u32 v131, 256, v225
    v_mul_lo_u32 v132, s3, v131
    v_lshrrev_b32 v132, 20, v132
    v_mul_u32_u24 v133, 20, v132
    v_sub_u32 v133, v131, v133
    v_bfe_u32 v134, v132, 3, 1
    v_lshlrev_b32 v134, 1, v134
    v_xor_b32 v133, v133, v134
    v_mul_u32_u24 v132, 1152, v132
    v_lshl_add_u32 v132, v133, 4, v132
    ds_write_b128 v116, v[172:175] offset:1024
    v_mfma_f32_32x32x16_bf16 v[16:31], v[248:251], v[152:155], v[16:31]
    ds_read_b64_tr_b16 v[248:249], v228 offset:10240
    ds_read_b64_tr_b16 v[250:251], v228 offset:14336
    v_add_u32 v124, 3072, v132
    v_lshrrev_b32 v131, 4, v225
    v_bfe_u32 v132, v225, 2, 2
    v_lshl_add_u32 v132, v131, 3, v132
    v_mul_u32_u24 v132, 320, v132
    v_bfe_u32 v133, v225, 1, 1
    v_lshl_add_u32 v132, v133, 4, v132
    v_and_b32 v133, 1, v225
    v_lshl_add_u32 v132, v133, 3, v132
    v_and_b32 v133, 1, v131
    ds_write_b128 v116, v[176:179] offset:8192
    s_waitcnt lgkmcnt(10)
    v_mfma_f32_32x32x16_bf16 v[32:47], v[252:255], v[152:155], v[32:47]
    ds_read_b64_tr_b16 v[252:253], v229 offset:10240
    ds_read_b64_tr_b16 v[254:255], v229 offset:14336
    v_lshl_add_u32 v134, v133, 5, v132
    v_xor_b32 v135, 1, v133
    v_lshl_add_u32 v135, v135, 5, v132
    v_add_u32 v136, 64, v134
    s_bitcmp0_b32 s56, 0
    s_cselect_b64 vcc, -1, 0
    s_lshl_b32 s3, s25, 6
    v_cndmask_b32 v125, v135, v134, vcc
    v_cndmask_b32 v126, v136, v135, vcc
    v_add_u32 v127, s3, v125
    ds_write_b128 v116, v[180:183] offset:9216
    v_mfma_f32_32x32x16_bf16 v[48:63], v[236:239], v[152:155], v[48:63]
    v_add_u32 v128, s3, v126
    v_and_b32 v132, 15, v225
    v_lshlrev_b32 v132, 4, v132
    v_lshrrev_b32 v131, 1, v131
    v_lshl_add_u32 v134, v133, 9, v132
    v_lshl_add_u32 v134, v131, 10, v134
    v_add_u32 v129, s62, v134
    v_lshl_add_u32 v134, v133, 8, v132
    v_lshl_add_u32 v134, v131, 9, v134
    v_add_u32 v130, 98304, v134
    ds_write_b128 v117, v[184:187] offset:0
    s_waitcnt lgkmcnt(8)
    v_mfma_f32_32x32x16_bf16 v[0:15], v[240:243], v[156:159], v[0:15]
    s_mul_i32 s6, s26, 36864
    s_lshl_b32 s7, s25, 12
    s_add_u32 s6, s6, s7
    s_add_u32 s6, s6, 81920
    v_add_u32 v233, s6, v220
    s_lshl_b32 s6, s24, 7
    s_add_u32 s6, s6, 20480
    v_add_u32 v92, s6, v119
    v_xor_b32 v93, 0x80, v92
    v_xor_b32 v94, 0x100, v92
    ds_write_b128 v117, v[188:191] offset:1024
    v_mfma_f32_32x32x16_bf16 v[16:31], v[244:247], v[156:159], v[16:31]
    v_xor_b32 v95, 0x180, v92
    s_xor_b32 s7, s25, 1
    s_lshl_b32 s7, s7, 11
    s_add_u32 s7, s7, s45
    v_add_u32 v89, s7, v220
    s_xor_b32 s7, s25, 2
    s_lshl_b32 s7, s7, 11
    s_add_u32 s7, s7, s45
    s_add_u32 s7, s7, 8192
    v_add_u32 v90, s7, v220
    s_waitcnt lgkmcnt(3)
    v_mfma_f32_32x32x16_bf16 v[32:47], v[248:251], v[156:159], v[32:47]
    s_xor_b32 s7, s25, 3
    s_lshl_b32 s7, s7, 11
    s_add_u32 s7, s7, s46
    v_add_u32 v91, s7, v220
    v_lshrrev_b32 v131, 5, v225
    v_bfe_u32 v132, v225, 4, 1
    v_lshlrev_b32 v137, 1, v119
    v_lshl_add_u32 v137, v131, 8, v137
    v_lshl_add_u32 v137, v132, 3, v137
    s_lshr_b32 s6, s24, 1
    v_mfma_f32_32x32x16_bf16 v[48:63], v[252:255], v[156:159], v[48:63]
    s_mul_i32 s6, s6, 18432
    s_and_b32 s7, s24, 1
    s_lshl_b32 s7, s7, 10
    s_add_u32 s6, s6, s7
    s_add_u32 s6, s6, 98304
    v_add_u32 v138, s6, v137
    s_waitcnt lgkmcnt(0)
    s_barrier
    ds_read_b64 v[96:97], v92
    ds_read_b64 v[98:99], v93
    ds_read_b64 v[100:101], v94
    ds_read_b64 v[102:103], v95
    ds_read_b128 v[192:195], v89 offset:0
    ds_read_b128 v[196:199], v89 offset:1024
    ds_read_b128 v[200:203], v90 offset:0
    ds_read_b128 v[204:207], v90 offset:1024
    ds_read_b128 v[144:147], v91 offset:0
    ds_read_b128 v[148:151], v91 offset:1024
    s_cmp_lt_u32 s24, 4
    s_cbranch_scc0 K1_Z
    s_mul_i32 s7, s63, 73728
    s_add_u32 s7, s7, s59
    s_add_u32 m0, s31, s61
    s_add_u32 s63, s63, 1
    buffer_load_dwordx4 v120, s[8:11], s7 offen offset:0  lds
    buffer_load_dwordx4 v121, s[8:11], s7 offen offset:1024  lds
    buffer_load_dwordx4 v122, s[8:11], s7 offen offset:2048  lds
    buffer_load_dwordx4 v123, s[8:11], s7 offen offset:3072  lds
    s_add_u32 m0, m0, 4096
    s_nop 0
    buffer_load_dwordx4 v124, s[8:11], s7 offen offset:0  lds
    s_and_b32 s63, s63, 15
    s_add_u32 s31, s31, 20480
    s_cmp_eq_u32 s31, 81920
    s_cselect_b32 s31, 0, s31
    s_waitcnt lgkmcnt(0)
    s_barrier
K1_Z:
    v_mul_f32 v0, v0, v232
    v_mul_f32 v1, v1, v232
    v_mul_f32 v2, v2, v232
    v_mul_f32 v3, v3, v232
    v_mul_f32 v4, v4, v232
    v_mul_f32 v5, v5, v232
    v_mul_f32 v6, v6, v232
    v_mul_f32 v7, v7, v232
    v_mul_f32 v8, v8, v232
    v_mul_f32 v9, v9, v232
    v_mul_f32 v10, v10, v232
    v_mul_f32 v11, v11, v232
    v_mul_f32 v12, v12, v232
    v_mul_f32 v13, v13, v232
    v_mul_f32 v14, v14, v232
    v_mul_f32 v15, v15, v232
    v_cvt_pk_bf16_f32 v64, v0, v1
    v_cvt_pk_bf16_f32 v65, v2, v3
    v_cvt_pk_bf16_f32 v66, v4, v5
    v_cvt_pk_bf16_f32 v67, v6, v7
    ds_write_b128 v233, v[64:67] offset:0
    buffer_store_dwordx4 v[64:67], v220, s[20:23], s41 offen offset:0
    v_cvt_pk_bf16_f32 v68, v8, v9
    v_cvt_pk_bf16_f32 v69, v10, v11
    v_cvt_pk_bf16_f32 v70, v12, v13
    v_cvt_pk_bf16_f32 v71, v14, v15
    ds_write_b128 v233, v[68:71] offset:1024
    buffer_store_dwordx4 v[68:71], v220, s[20:23], s41 offen offset:1024
    s_waitcnt lgkmcnt(9)
    v_min3_f32 v104, v96, v98, v100
    s_waitcnt lgkmcnt(8)
    v_min_f32 v104, v104, v102
    v_sub_f32 v96, v104, v96
    v_sub_f32 v98, v104, v98
    v_sub_f32 v100, v104, v100
    v_sub_f32 v102, v104, v102
    v_exp_f32 v96, v96
    v_exp_f32 v98, v98
    v_exp_f32 v100, v100
    v_exp_f32 v102, v102
    v_mul_f32 v105, v96, v97
    v_fmac_f32 v105, v98, v99
    v_fmac_f32 v105, v100, v101
    v_fmac_f32 v105, v102, v103
    v_rcp_f32 v105, v105
    v_mul_f32 v152, v160, v96
    v_mul_f32 v153, v161, v96
    v_mul_f32 v154, v162, v96
    v_mul_f32 v155, v163, v96
    v_mul_f32 v156, v164, v96
    v_mul_f32 v157, v165, v96
    v_mul_f32 v158, v166, v96
    v_mul_f32 v159, v167, v96
    s_waitcnt lgkmcnt(7)
    v_fmac_f32 v152, v192, v98
    v_fmac_f32 v153, v193, v98
    v_fmac_f32 v154, v194, v98
    v_fmac_f32 v155, v195, v98
    s_waitcnt lgkmcnt(6)
    v_fmac_f32 v156, v196, v98
    v_fmac_f32 v157, v197, v98
    v_fmac_f32 v158, v198, v98
    v_fmac_f32 v159, v199, v98
    s_waitcnt lgkmcnt(5)
    v_fmac_f32 v152, v200, v100
    v_fmac_f32 v153, v201, v100
    v_fmac_f32 v154, v202, v100
    v_fmac_f32 v155, v203, v100
    s_waitcnt lgkmcnt(4)
    v_fmac_f32 v156, v204, v100
    v_fmac_f32 v157, v205, v100
    v_fmac_f32 v158, v206, v100
    v_fmac_f32 v159, v207, v100
    s_waitcnt lgkmcnt(3)
    v_fmac_f32 v152, v144, v102
    v_fmac_f32 v153, v145, v102
    v_fmac_f32 v154, v146, v102
    v_fmac_f32 v155, v147, v102
    s_waitcnt lgkmcnt(2)
    v_fmac_f32 v156, v148, v102
    v_fmac_f32 v157, v149, v102
    v_fmac_f32 v158, v150, v102
    v_fmac_f32 v159, v151, v102
    v_mul_f32 v152, v152, v105
    v_mul_f32 v153, v153, v105
    v_mul_f32 v154, v154, v105
    v_mul_f32 v155, v155, v105
    v_mul_f32 v156, v156, v105
    v_mul_f32 v157, v157, v105
    v_mul_f32 v158, v158, v105
    v_mul_f32 v159, v159, v105
    v_cvt_pk_bf16_f32 v106, v152, v153
    v_cvt_pk_bf16_f32 v107, v154, v155
    ds_write_b64 v138, v[106:107] offset:0
    buffer_store_dwordx2 v[106:107], v137, s[20:23], s40 offen offset:0
    v_cvt_pk_bf16_f32 v108, v156, v157
    v_cvt_pk_bf16_f32 v109, v158, v159
    ds_write_b64 v138, v[108:109] offset:512
    buffer_store_dwordx2 v[108:109], v137, s[20:23], s40 offen offset:512
    v_mul_f32 v16, v16, v232
    v_mul_f32 v17, v17, v232
    v_mul_f32 v18, v18, v232
    v_mul_f32 v19, v19, v232
    v_mul_f32 v20, v20, v232
    v_mul_f32 v21, v21, v232
    v_mul_f32 v22, v22, v232
    v_mul_f32 v23, v23, v232
    v_mul_f32 v24, v24, v232
    v_mul_f32 v25, v25, v232
    v_mul_f32 v26, v26, v232
    v_mul_f32 v27, v27, v232
    v_mul_f32 v28, v28, v232
    v_mul_f32 v29, v29, v232
    v_mul_f32 v30, v30, v232
    v_mul_f32 v31, v31, v232
    v_cvt_pk_bf16_f32 v72, v16, v17
    v_cvt_pk_bf16_f32 v73, v18, v19
    v_cvt_pk_bf16_f32 v74, v20, v21
    v_cvt_pk_bf16_f32 v75, v22, v23
    ds_write_b128 v233, v[72:75] offset:2048
    buffer_store_dwordx4 v[72:75], v220, s[20:23], s41 offen offset:2048
    v_cvt_pk_bf16_f32 v76, v24, v25
    v_cvt_pk_bf16_f32 v77, v26, v27
    v_cvt_pk_bf16_f32 v78, v28, v29
    v_cvt_pk_bf16_f32 v79, v30, v31
    ds_write_b128 v233, v[76:79] offset:3072
    buffer_store_dwordx4 v[76:79], v220, s[20:23], s41 offen offset:3072
    v_mul_f32 v32, v32, v232
    v_mul_f32 v33, v33, v232
    v_mul_f32 v34, v34, v232
    v_mul_f32 v35, v35, v232
    v_mul_f32 v36, v36, v232
    v_mul_f32 v37, v37, v232
    v_mul_f32 v38, v38, v232
    v_mul_f32 v39, v39, v232
    v_mul_f32 v40, v40, v232
    v_mul_f32 v41, v41, v232
    v_mul_f32 v42, v42, v232
    v_mul_f32 v43, v43, v232
    v_mul_f32 v44, v44, v232
    v_mul_f32 v45, v45, v232
    v_mul_f32 v46, v46, v232
    v_mul_f32 v47, v47, v232
    v_cvt_pk_bf16_f32 v80, v32, v33
    v_cvt_pk_bf16_f32 v81, v34, v35
    v_cvt_pk_bf16_f32 v82, v36, v37
    v_cvt_pk_bf16_f32 v83, v38, v39
    ds_write_b128 v233, v[80:83] offset:18432
    buffer_store_dwordx4 v[80:83], v220, s[20:23], s42 offen offset:0
    v_cvt_pk_bf16_f32 v84, v40, v41
    v_cvt_pk_bf16_f32 v85, v42, v43
    v_cvt_pk_bf16_f32 v86, v44, v45
    v_cvt_pk_bf16_f32 v87, v46, v47
    ds_write_b128 v233, v[84:87] offset:19456
    buffer_store_dwordx4 v[84:87], v220, s[20:23], s42 offen offset:1024
    v_mul_f32 v48, v48, v232
    v_mul_f32 v49, v49, v232
    v_mul_f32 v50, v50, v232
    v_mul_f32 v51, v51, v232
    v_mul_f32 v52, v52, v232
    v_mul_f32 v53, v53, v232
    v_mul_f32 v54, v54, v232
    v_mul_f32 v55, v55, v232
    v_mul_f32 v56, v56, v232
    v_mul_f32 v57, v57, v232
    v_mul_f32 v58, v58, v232
    v_mul_f32 v59, v59, v232
    v_mul_f32 v60, v60, v232
    v_mul_f32 v61, v61, v232
    v_mul_f32 v62, v62, v232
    v_mul_f32 v63, v63, v232
    v_cvt_pk_bf16_f32 v88, v48, v49
    v_cvt_pk_bf16_f32 v89, v50, v51
    v_cvt_pk_bf16_f32 v90, v52, v53
    v_cvt_pk_bf16_f32 v91, v54, v55
    ds_write_b128 v233, v[88:91] offset:20480
    buffer_store_dwordx4 v[88:91], v220, s[20:23], s42 offen offset:2048
    v_cvt_pk_bf16_f32 v92, v56, v57
    v_cvt_pk_bf16_f32 v93, v58, v59
    v_cvt_pk_bf16_f32 v94, v60, v61
    v_cvt_pk_bf16_f32 v95, v62, v63
    ds_write_b128 v233, v[92:95] offset:21504
    buffer_store_dwordx4 v[92:95], v220, s[20:23], s42 offen offset:3072
    s_cmp_ge_u32 s24, 4
    s_cbranch_scc1 P2_G1
    s_setprio 2
    s_waitcnt vmcnt(0)
    s_waitcnt lgkmcnt(0)
    s_barrier
    s_getreg_b32 s3, hwreg(HW_REG_XCC_ID, 0, 4)
    s_lshl_b32 s7, s34, 4
    s_add_u32 s3, s3, s7
    v_cmp_eq_u32 vcc, s3, v115
    s_and_b32 s47, vcc_lo, 15
    s_add_u32 s37, s48, 16384
    v_mov_b32 v137, 163832
    v_mov_b32 v138, 0
    ds_write_b32 v137, v138
    s_mul_i32 s7, s63, 73728
    s_add_u32 s7, s7, s59
    s_add_u32 m0, s31, s61
    s_add_u32 s63, s63, 1
    buffer_load_dwordx4 v120, s[8:11], s7 offen offset:0  lds
    buffer_load_dwordx4 v121, s[8:11], s7 offen offset:1024  lds
    buffer_load_dwordx4 v122, s[8:11], s7 offen offset:2048  lds
    buffer_load_dwordx4 v123, s[8:11], s7 offen offset:3072  lds
    s_add_u32 m0, m0, 4096
    s_nop 0
    buffer_load_dwordx4 v124, s[8:11], s7 offen offset:0  lds
    s_and_b32 s63, s63, 15
    s_add_u32 s31, s31, 20480
    s_cmp_eq_u32 s31, 81920
    s_cselect_b32 s31, 0, s31
    s_mul_i32 s7, s63, 73728
    s_add_u32 s7, s7, s59
    s_add_u32 m0, s31, s61
    s_add_u32 s63, s63, 1
    buffer_load_dwordx4 v120, s[8:11], s7 offen offset:0  lds
    buffer_load_dwordx4 v121, s[8:11], s7 offen offset:1024  lds
    buffer_load_dwordx4 v122, s[8:11], s7 offen offset:2048  lds
    buffer_load_dwordx4 v123, s[8:11], s7 offen offset:3072  lds
    s_add_u32 m0, m0, 4096
    s_nop 0
    buffer_load_dwordx4 v124, s[8:11], s7 offen offset:0  lds
    s_and_b32 s63, s63, 15
    s_add_u32 s31, s31, 20480
    s_cmp_eq_u32 s31, 81920
    s_cselect_b32 s31, 0, s31
    s_mul_i32 s7, s63, 73728
    s_add_u32 s7, s7, s59
    s_add_u32 m0, s31, s61
    s_add_u32 s63, s63, 1
    buffer_load_dwordx4 v120, s[8:11], s7 offen offset:0  lds
    buffer_load_dwordx4 v121, s[8:11], s7 offen offset:1024  lds
    buffer_load_dwordx4 v122, s[8:11], s7 offen offset:2048  lds
    buffer_load_dwordx4 v123, s[8:11], s7 offen offset:3072  lds
    s_add_u32 m0, m0, 4096
    s_nop 0
    buffer_load_dwordx4 v124, s[8:11], s7 offen offset:0  lds
    s_and_b32 s63, s63, 15
    s_add_u32 s31, s31, 20480
    s_cmp_eq_u32 s31, 81920
    s_cselect_b32 s31, 0, s31
    s_cmp_lg_u32 s24, 0
    s_cbranch_scc1 P2_F0
    s_mov_b64 exec, 0xff
    s_cmp_eq_u32 s47, 15
    s_cbranch_scc1 P2_F1L
    buffer_load_dword v143, v142, s[52:55], s48 offen sc1
    s_branch P2_F1M
P2_F1L:
    buffer_load_dword v143, v142, s[52:55], s37 offen nt
P2_F1M:
    s_mov_b64 exec, -1
P2_F0:
    s_waitcnt vmcnt(10)
    s_waitcnt lgkmcnt(0)
    s_barrier
    s_waitcnt vmcnt(5)
    s_barrier
    s_waitcnt vmcnt(0)
    s_mov_b32 s33, 0
    s_mov_b32 s30, 2
    s_sub_u32 s63, s63, 2
P2_LD:
    s_cmp_eq_u32 s30, 8
    s_cselect_b32 s3, 8, 2
    s_cselect_b32 s33, 4, s33
    s_add_u32 s63, s63, s3
    s_and_b32 s63, s63, 15
    s_cmp_lg_u32 s24, 0
    s_cbranch_scc1 P2_PO
    s_lshr_b32 s3, s63, 2
    s_add_u32 s3, s3, s33
    s_mov_b32 s44, 200000
P2_PF:
    v_cmp_eq_u32 vcc, s34, v143
    s_bitcmp1_b32 vcc_lo, s3
    s_cbranch_scc1 P2_PG
    s_mov_b64 exec, 0xff
    s_cmp_eq_u32 s47, 15
    s_cbranch_scc1 P2_F2L
    buffer_load_dword v143, v142, s[52:55], s48 offen sc1
    s_branch P2_F2M
P2_F2L:
    buffer_load_dword v143, v142, s[52:55], s37 offen nt
P2_F2M:
    s_mov_b64 exec, -1
    s_sub_u32 s44, s44, 1
    s_waitcnt vmcnt(0)
    s_cbranch_scc0 P2_PF
P2_PG:
    v_mov_b32 v138, s30
    ds_write_b32 v137, v138
    s_cmp_lg_u32 s30, 6
    s_cbranch_scc1 P2_PN
    s_mov_b64 exec, 0xff
    s_cmp_eq_u32 s47, 15
    s_cbranch_scc1 P2_F3L
    buffer_load_dword v143, v142, s[52:55], s48 offen sc1
    s_branch P2_F3M
P2_F3L:
    buffer_load_dword v143, v142, s[52:55], s37 offen nt
P2_F3M:
    s_mov_b64 exec, -1
    s_branch P2_PN
P2_PO:
    ds_read_b32 v138, v137
    s_waitcnt lgkmcnt(0)
    v_readfirstlane_b32 s6, v138
    s_cmp_eq_u32 s6, s30
    s_cbranch_scc0 P2_PO
P2_PN:
    s_mov_b32 s35, s63
    s_add_u32 m0, s36, s62
    s_lshl_b32 s7, s35, 12
    s_add_u32 s7, s7, s60
    buffer_load_dwordx4 v141, s[20:23], s7 offen offset:0  lds
    buffer_load_dwordx4 v141, s[20:23], s7 offen offset:1024  lds
    buffer_load_dwordx4 v141, s[20:23], s7 offen offset:2048  lds
    buffer_load_dwordx4 v141, s[20:23], s7 offen offset:3072  lds
    s_add_u32 m0, s36, s43
    s_lshl_b32 s7, s35, 11
    s_add_u32 s7, s7, s57
    s_mov_b32 exec_hi, 0
    buffer_load_dwordx4 v141, s[20:23], s7 offen  lds
    s_mov_b32 exec_hi, -1
    s_add_u32 s35, s35, 1
    s_and_b32 s35, s35, 15
    s_add_u32 s36, s36, 18432
    s_cmp_eq_u32 s36, 73728
    s_cselect_b32 s36, 0, s36
    s_mul_i32 s7, s63, 73728
    s_add_u32 s7, s7, s59
    s_add_u32 m0, s31, s61
    s_add_u32 s63, s63, 1
    buffer_load_dwordx4 v120, s[8:11], s7 offen offset:0  lds
    buffer_load_dwordx4 v121, s[8:11], s7 offen offset:1024  lds
    buffer_load_dwordx4 v122, s[8:11], s7 offen offset:2048  lds
    buffer_load_dwordx4 v123, s[8:11], s7 offen offset:3072  lds
    s_add_u32 m0, m0, 4096
    s_nop 0
    buffer_load_dwordx4 v124, s[8:11], s7 offen offset:0  lds
    s_and_b32 s63, s63, 15
    s_add_u32 s31, s31, 20480
    s_cmp_eq_u32 s31, 81920
    s_cselect_b32 s31, 0, s31
    s_waitcnt vmcnt(10)
    s_waitcnt lgkmcnt(0)
    s_barrier
    s_add_u32 m0, s36, s62
    s_lshl_b32 s7, s35, 12
    s_add_u32 s7, s7, s60
    buffer_load_dwordx4 v141, s[20:23], s7 offen offset:0  lds
    buffer_load_dwordx4 v141, s[20:23], s7 offen offset:1024  lds
    buffer_load_dwordx4 v141, s[20:23], s7 offen offset:2048  lds
    buffer_load_dwordx4 v141, s[20:23], s7 offen offset:3072  lds
    s_add_u32 m0, s36, s43
    s_lshl_b32 s7, s35, 11
    s_add_u32 s7, s7, s57
    s_mov_b32 exec_hi, 0
    buffer_load_dwordx4 v141, s[20:23], s7 offen  lds
    s_mov_b32 exec_hi, -1
    s_add_u32 s35, s35, 1
    s_and_b32 s35, s35, 15
    s_add_u32 s36, s36, 18432
    s_cmp_eq_u32 s36, 73728
    s_cselect_b32 s36, 0, s36
    s_mul_i32 s7, s63, 73728
    s_add_u32 s7, s7, s59
    s_add_u32 m0, s31, s61
    s_add_u32 s63, s63, 1
    buffer_load_dwordx4 v120, s[8:11], s7 offen offset:0  lds
    buffer_load_dwordx4 v121, s[8:11], s7 offen offset:1024  lds
    buffer_load_dwordx4 v122, s[8:11], s7 offen offset:2048  lds
    buffer_load_dwordx4 v123, s[8:11], s7 offen offset:3072  lds
    s_add_u32 m0, m0, 4096
    s_nop 0
    buffer_load_dwordx4 v124, s[8:11], s7 offen offset:0  lds
    s_and_b32 s63, s63, 15
    s_add_u32 s31, s31, 20480
    s_cmp_eq_u32 s31, 81920
    s_cselect_b32 s31, 0, s31
    s_add_u32 s30, s30, 2
    s_cmp_lt_u32 s30, 14
    s_waitcnt vmcnt(10)
    s_barrier
    s_cbranch_scc1 P2_LD
    s_waitcnt vmcnt(0)
    s_barrier
    s_barrier
    s_branch P2_RED
P2_G1:
    s_setprio 0
    s_lshl_b32 s6, s58, 2
    s_add_u32 s6, s6, s51
    s_lshl_b32 s6, s6, 2
    s_add_u32 s6, s6, s25
    s_mul_i32 s6, s6, 11264
    s_add_u32 s6, s6, 20971520
    s_add_u32 s16, s66, s6
    s_addc_u32 s17, s67, 0
    s_mov_b32 s18, 11264
    s_mov_b32 s19, 0x20000
    s_mov_b32 s36, 0
    s_mov_b32 s30, 1
    s_mov_b32 s37, 20480
    s_mov_b32 s47, 18432
    s_lshl_b32 s6, s56, 2
    s_add_u32 s48, s6, s48
    s_waitcnt lgkmcnt(0)
    s_barrier
    s_cmp_eq_u32 s24, 4
    s_cbranch_scc0 P2_FA
    s_add_u32 s44, s48, 16384
    s_mov_b64 exec, 1
    buffer_store_dword v143, v142, s[52:55], s44 offen
    s_mov_b64 exec, -1
    s_getreg_b32 s3, hwreg(HW_REG_XCC_ID, 0, 4)
    s_lshl_b32 s7, s34, 4
    s_add_u32 s3, s3, s7
    s_waitcnt vmcnt(11)
    v_cmp_eq_u32 vcc, s3, v115
    s_and_b32 s33, vcc_lo, 15
    s_cmp_eq_u32 s33, 15
    s_cbranch_scc1 P2_WA
    buffer_wbl2 sc1
    s_waitcnt vmcnt(0)
P2_WA:
    s_mov_b64 exec, 1
    buffer_store_dword v143, v142, s[52:55], s48 offen sc1
    s_mov_b64 exec, -1
P2_FA:
    ds_read_b128 v[188:191], v129 offset:0
    ds_read_b128 v[192:195], v129 offset:256
    ds_read_b64_tr_b16 v[144:145], v125 offset:0
    ds_read_b64_tr_b16 v[146:147], v125 offset:1280
    ds_read_b64_tr_b16 v[148:149], v126 offset:0
    ds_read_b64_tr_b16 v[150:151], v126 offset:1280
    ds_read_b64_tr_b16 v[152:153], v125 offset:64
    ds_read_b64_tr_b16 v[154:155], v125 offset:1344
    ds_read_b64_tr_b16 v[156:157], v126 offset:64
    ds_read_b64_tr_b16 v[158:159], v126 offset:1344
    ds_read_b64_tr_b16 v[160:161], v125 offset:128
    ds_read_b64_tr_b16 v[162:163], v125 offset:1408
    ds_read_b64_tr_b16 v[164:165], v126 offset:128
    ds_read_b64_tr_b16 v[166:167], v126 offset:1408
    ds_read_b64_tr_b16 v[168:169], v125 offset:192
    ds_read_b64_tr_b16 v[170:171], v125 offset:1472
    ds_read_b64_tr_b16 v[172:173], v126 offset:192
    ds_read_b64_tr_b16 v[174:175], v126 offset:1472
    ds_read_b128 v[196:199], v130 offset:0
    ds_read_b64_tr_b16 v[176:177], v125 offset:256
    ds_read_b64_tr_b16 v[178:179], v125 offset:1536
    ds_read_b64_tr_b16 v[180:181], v127 offset:0
    ds_read_b64_tr_b16 v[182:183], v127 offset:1280
    ds_read_b64_tr_b16 v[184:185], v128 offset:0
    ds_read_b64_tr_b16 v[186:187], v128 offset:1280
    s_waitcnt lgkmcnt(15)
    v_mfma_f32_16x16x32_bf16 v[0:3], v[144:147], v[188:191], 0
    ds_read_b128 v[244:247], v129 offset:2048
    ds_read_b128 v[248:251], v129 offset:2304
    v_mfma_f32_16x16x32_bf16 v[4:7], v[144:147], v[192:195], 0
    ds_read_b64_tr_b16 v[200:201], v125 offset:10240
    ds_read_b64_tr_b16 v[202:203], v125 offset:11520
    v_mfma_f32_16x16x32_bf16 v[8:11], v[148:151], v[188:191], 0
    ds_read_b64_tr_b16 v[204:205], v126 offset:10240
    v_mfma_f32_16x16x32_bf16 v[12:15], v[148:151], v[192:195], 0
    ds_read_b64_tr_b16 v[206:207], v126 offset:11520
    ds_read_b64_tr_b16 v[208:209], v125 offset:10304
    v_mfma_f32_16x16x32_bf16 v[16:19], v[152:155], v[188:191], 0
    ds_read_b64_tr_b16 v[210:211], v125 offset:11584
    ds_read_b64_tr_b16 v[212:213], v126 offset:10304
    v_mfma_f32_16x16x32_bf16 v[20:23], v[152:155], v[192:195], 0
    ds_read_b64_tr_b16 v[214:215], v126 offset:11584
    s_waitcnt lgkmcnt(15)
    v_mfma_f32_16x16x32_bf16 v[24:27], v[156:159], v[188:191], 0
    ds_read_b64_tr_b16 v[216:217], v125 offset:10368
    ds_read_b64_tr_b16 v[218:219], v125 offset:11648
    v_mfma_f32_16x16x32_bf16 v[28:31], v[156:159], v[192:195], 0
    ds_read_b64_tr_b16 v[220:221], v126 offset:10368
    ds_read_b64_tr_b16 v[222:223], v126 offset:11648
    v_mfma_f32_16x16x32_bf16 v[32:35], v[160:163], v[188:191], 0
    ds_read_b64_tr_b16 v[224:225], v125 offset:10432
    v_mfma_f32_16x16x32_bf16 v[36:39], v[160:163], v[192:195], 0
    ds_read_b64_tr_b16 v[226:227], v125 offset:11712
    ds_read_b64_tr_b16 v[228:229], v126 offset:10432
    v_mfma_f32_16x16x32_bf16 v[40:43], v[164:167], v[188:191], 0
    ds_read_b64_tr_b16 v[230:231], v126 offset:11712
    ds_read_b128 v[252:255], v130 offset:1024
    v_mfma_f32_16x16x32_bf16 v[44:47], v[164:167], v[192:195], 0
    ds_read_b64_tr_b16 v[232:233], v125 offset:10496
    s_waitcnt lgkmcnt(15)
    v_mfma_f32_16x16x32_bf16 v[48:51], v[168:171], v[188:191], 0
    ds_read_b64_tr_b16 v[234:235], v125 offset:11776
    ds_read_b64_tr_b16 v[236:237], v127 offset:10240
    v_mfma_f32_16x16x32_bf16 v[52:55], v[168:171], v[192:195], 0
    ds_read_b64_tr_b16 v[238:239], v127 offset:11520
    ds_read_b64_tr_b16 v[240:241], v128 offset:10240
    v_mfma_f32_16x16x32_bf16 v[56:59], v[172:175], v[188:191], 0
    ds_read_b64_tr_b16 v[242:243], v128 offset:11520
    v_mfma_f32_16x16x32_bf16 v[60:63], v[172:175], v[192:195], 0
    v_add_u32 v125, s37, v125
    v_add_u32 v126, s37, v126
    v_mfma_f32_16x16x32_bf16 v[64:67], v[176:179], v[188:191], 0
    v_add_u32 v127, s37, v127
    v_add_u32 v128, s37, v128
    v_mfma_f32_16x16x32_bf16 v[68:71], v[176:179], v[192:195], 0
    v_add_u32 v129, s47, v129
    v_add_u32 v130, s47, v130
    v_mfma_f32_16x16x32_bf16 v[80:83], v[176:179], v[196:199], 0
    v_mfma_f32_16x16x32_bf16 v[72:75], v[180:183], v[196:199], 0
    v_mfma_f32_16x16x32_bf16 v[76:79], v[184:187], v[196:199], 0
    s_waitcnt lgkmcnt(0)
    s_barrier
    s_branch P2_M
P2_L:
    s_waitcnt lgkmcnt(15)
    v_mfma_f32_16x16x32_bf16 v[0:3], v[144:147], v[188:191], v[0:3]
    ds_read_b128 v[244:247], v129 offset:2048
    ds_read_b128 v[248:251], v129 offset:2304
    v_mfma_f32_16x16x32_bf16 v[4:7], v[144:147], v[192:195], v[4:7]
    ds_read_b64_tr_b16 v[200:201], v125 offset:10240
    ds_read_b64_tr_b16 v[202:203], v125 offset:11520
    v_mfma_f32_16x16x32_bf16 v[8:11], v[148:151], v[188:191], v[8:11]
    ds_read_b64_tr_b16 v[204:205], v126 offset:10240
    v_mfma_f32_16x16x32_bf16 v[12:15], v[148:151], v[192:195], v[12:15]
    ds_read_b64_tr_b16 v[206:207], v126 offset:11520
    ds_read_b64_tr_b16 v[208:209], v125 offset:10304
    v_mfma_f32_16x16x32_bf16 v[16:19], v[152:155], v[188:191], v[16:19]
    ds_read_b64_tr_b16 v[210:211], v125 offset:11584
    ds_read_b64_tr_b16 v[212:213], v126 offset:10304
    v_mfma_f32_16x16x32_bf16 v[20:23], v[152:155], v[192:195], v[20:23]
    ds_read_b64_tr_b16 v[214:215], v126 offset:11584
    s_waitcnt lgkmcnt(15)
    v_mfma_f32_16x16x32_bf16 v[24:27], v[156:159], v[188:191], v[24:27]
    ds_read_b64_tr_b16 v[216:217], v125 offset:10368
    ds_read_b64_tr_b16 v[218:219], v125 offset:11648
    v_mfma_f32_16x16x32_bf16 v[28:31], v[156:159], v[192:195], v[28:31]
    ds_read_b64_tr_b16 v[220:221], v126 offset:10368
    ds_read_b64_tr_b16 v[222:223], v126 offset:11648
    v_mfma_f32_16x16x32_bf16 v[32:35], v[160:163], v[188:191], v[32:35]
    ds_read_b64_tr_b16 v[224:225], v125 offset:10432
    v_mfma_f32_16x16x32_bf16 v[36:39], v[160:163], v[192:195], v[36:39]
    ds_read_b64_tr_b16 v[226:227], v125 offset:11712
    ds_read_b64_tr_b16 v[228:229], v126 offset:10432
    v_mfma_f32_16x16x32_bf16 v[40:43], v[164:167], v[188:191], v[40:43]
    ds_read_b64_tr_b16 v[230:231], v126 offset:11712
    ds_read_b128 v[252:255], v130 offset:1024
    v_mfma_f32_16x16x32_bf16 v[44:47], v[164:167], v[192:195], v[44:47]
    ds_read_b64_tr_b16 v[232:233], v125 offset:10496
    s_waitcnt lgkmcnt(15)
    v_mfma_f32_16x16x32_bf16 v[48:51], v[168:171], v[188:191], v[48:51]
    ds_read_b64_tr_b16 v[234:235], v125 offset:11776
    ds_read_b64_tr_b16 v[236:237], v127 offset:10240
    v_mfma_f32_16x16x32_bf16 v[52:55], v[168:171], v[192:195], v[52:55]
    ds_read_b64_tr_b16 v[238:239], v127 offset:11520
    ds_read_b64_tr_b16 v[240:241], v128 offset:10240
    v_mfma_f32_16x16x32_bf16 v[56:59], v[172:175], v[188:191], v[56:59]
    ds_read_b64_tr_b16 v[242:243], v128 offset:11520
    v_mfma_f32_16x16x32_bf16 v[60:63], v[172:175], v[192:195], v[60:63]
    v_add_u32 v125, s37, v125
    v_add_u32 v126, s37, v126
    v_mfma_f32_16x16x32_bf16 v[64:67], v[176:179], v[188:191], v[64:67]
    v_add_u32 v127, s37, v127
    v_add_u32 v128, s37, v128
    v_mfma_f32_16x16x32_bf16 v[68:71], v[176:179], v[192:195], v[68:71]
    v_add_u32 v129, s47, v129
    v_add_u32 v130, s47, v130
    v_mfma_f32_16x16x32_bf16 v[80:83], v[176:179], v[196:199], v[80:83]
    s_add_u32 s30, s30, 1
    s_cmp_eq_u32 s30, 2
    v_mfma_f32_16x16x32_bf16 v[72:75], v[180:183], v[196:199], v[72:75]
    s_cbranch_scc1 P2_SPEC
    v_mfma_f32_16x16x32_bf16 v[76:79], v[184:187], v[196:199], v[76:79]
    s_waitcnt lgkmcnt(0)
    s_barrier
P2_M:
    v_mfma_f32_16x16x32_bf16 v[0:3], v[200:203], v[244:247], v[0:3]
    ds_read_b128 v[188:191], v129 offset:0
    ds_read_b128 v[192:195], v129 offset:256
    v_mfma_f32_16x16x32_bf16 v[4:7], v[200:203], v[248:251], v[4:7]
    ds_read_b64_tr_b16 v[144:145], v125 offset:0
    ds_read_b64_tr_b16 v[146:147], v125 offset:1280
    v_mfma_f32_16x16x32_bf16 v[8:11], v[204:207], v[244:247], v[8:11]
    ds_read_b64_tr_b16 v[148:149], v126 offset:0
    v_mfma_f32_16x16x32_bf16 v[12:15], v[204:207], v[248:251], v[12:15]
    ds_read_b64_tr_b16 v[150:151], v126 offset:1280
    ds_read_b64_tr_b16 v[152:153], v125 offset:64
    v_mfma_f32_16x16x32_bf16 v[16:19], v[208:211], v[244:247], v[16:19]
    ds_read_b64_tr_b16 v[154:155], v125 offset:1344
    ds_read_b64_tr_b16 v[156:157], v126 offset:64
    v_mfma_f32_16x16x32_bf16 v[20:23], v[208:211], v[248:251], v[20:23]
    ds_read_b64_tr_b16 v[158:159], v126 offset:1344
    v_mfma_f32_16x16x32_bf16 v[24:27], v[212:215], v[244:247], v[24:27]
    ds_read_b64_tr_b16 v[160:161], v125 offset:128
    ds_read_b64_tr_b16 v[162:163], v125 offset:1408
    v_mfma_f32_16x16x32_bf16 v[28:31], v[212:215], v[248:251], v[28:31]
    ds_read_b64_tr_b16 v[164:165], v126 offset:128
    ds_read_b64_tr_b16 v[166:167], v126 offset:1408
    v_mfma_f32_16x16x32_bf16 v[32:35], v[216:219], v[244:247], v[32:35]
    ds_read_b64_tr_b16 v[168:169], v125 offset:192
    v_mfma_f32_16x16x32_bf16 v[36:39], v[216:219], v[248:251], v[36:39]
    ds_read_b64_tr_b16 v[170:171], v125 offset:1472
    ds_read_b64_tr_b16 v[172:173], v126 offset:192
    v_mfma_f32_16x16x32_bf16 v[40:43], v[220:223], v[244:247], v[40:43]
    ds_read_b64_tr_b16 v[174:175], v126 offset:1472
    ds_read_b128 v[196:199], v130 offset:0
    v_mfma_f32_16x16x32_bf16 v[44:47], v[220:223], v[248:251], v[44:47]
    ds_read_b64_tr_b16 v[176:177], v125 offset:256
    v_mfma_f32_16x16x32_bf16 v[48:51], v[224:227], v[244:247], v[48:51]
    ds_read_b64_tr_b16 v[178:179], v125 offset:1536
    ds_read_b64_tr_b16 v[180:181], v127 offset:0
    v_mfma_f32_16x16x32_bf16 v[52:55], v[224:227], v[248:251], v[52:55]
    ds_read_b64_tr_b16 v[182:183], v127 offset:1280
    ds_read_b64_tr_b16 v[184:185], v128 offset:0
    v_mfma_f32_16x16x32_bf16 v[56:59], v[228:231], v[244:247], v[56:59]
    ds_read_b64_tr_b16 v[186:187], v128 offset:1280
    v_mfma_f32_16x16x32_bf16 v[60:63], v[228:231], v[248:251], v[60:63]
    s_add_u32 s36, s36, 1
    s_and_b32 s36, s36, 3
    v_mfma_f32_16x16x32_bf16 v[64:67], v[232:235], v[244:247], v[64:67]
    s_cmp_eq_u32 s36, 3
    s_mov_b32 s37, 20480
    s_cmov_b32 s37, 4294905856
    v_mfma_f32_16x16x32_bf16 v[68:71], v[232:235], v[248:251], v[68:71]
    s_mov_b32 s47, 18432
    s_cmov_b32 s47, 4294912000
    s_cmp_lt_u32 s30, 16
    v_mfma_f32_16x16x32_bf16 v[80:83], v[232:235], v[252:255], v[80:83]
    v_mfma_f32_16x16x32_bf16 v[72:75], v[236:239], v[252:255], v[72:75]
    v_mfma_f32_16x16x32_bf16 v[76:79], v[240:243], v[252:255], v[76:79]
    s_cbranch_scc1 P2_L
    s_branch P2_E
P2_SPEC:
    v_mfma_f32_16x16x32_bf16 v[76:79], v[184:187], v[196:199], v[76:79]
    s_waitcnt vmcnt(0)
    s_waitcnt lgkmcnt(0)
    s_barrier
    s_cmp_eq_u32 s24, 4
    s_cbranch_scc0 P2_M
    s_mov_b64 exec, 1
    buffer_store_dword v143, v142, s[52:55], s44 offen offset:16
    s_mov_b64 exec, -1
    s_cmp_eq_u32 s33, 15
    s_cbranch_scc1 P2_WB
    buffer_wbl2 sc1
    s_waitcnt vmcnt(0)
P2_WB:
    s_mov_b64 exec, 1
    buffer_store_dword v143, v142, s[52:55], s48 offen offset:16 sc1
    s_mov_b64 exec, -1
    s_branch P2_M
P2_E:
    s_cmp_eq_u32 s25, s51
    s_cbranch_scc1 P2_OWN
    v_cvt_pk_bf16_f32 v84, v0, v1
    v_cvt_pk_bf16_f32 v85, v2, v3
    v_cvt_pk_bf16_f32 v86, v8, v9
    v_cvt_pk_bf16_f32 v87, v10, v11
    s_mov_b32 s3, 0
    v_permlane16_swap_b32 v84, v86
    v_permlane16_swap_b32 v85, v87
    buffer_store_dwordx4 v[84:87], v141, s[16:19], s3 offen offset:0 sc1
    v_cvt_pk_bf16_f32 v88, v16, v17
    v_cvt_pk_bf16_f32 v89, v18, v19
    v_cvt_pk_bf16_f32 v90, v24, v25
    v_cvt_pk_bf16_f32 v91, v26, v27
    s_nop 0
    v_permlane16_swap_b32 v88, v90
    v_permlane16_swap_b32 v89, v91
    buffer_store_dwordx4 v[88:91], v141, s[16:19], s3 offen offset:1024 sc1
    v_cvt_pk_bf16_f32 v92, v32, v33
    v_cvt_pk_bf16_f32 v93, v34, v35
    v_cvt_pk_bf16_f32 v94, v40, v41
    v_cvt_pk_bf16_f32 v95, v42, v43
    s_nop 0
    v_permlane16_swap_b32 v92, v94
    v_permlane16_swap_b32 v93, v95
    buffer_store_dwordx4 v[92:95], v141, s[16:19], s3 offen offset:2048 sc1
    v_cvt_pk_bf16_f32 v96, v48, v49
    v_cvt_pk_bf16_f32 v97, v50, v51
    v_cvt_pk_bf16_f32 v98, v56, v57
    v_cvt_pk_bf16_f32 v99, v58, v59
    s_nop 0
    v_permlane16_swap_b32 v96, v98
    v_permlane16_swap_b32 v97, v99
    buffer_store_dwordx4 v[96:99], v141, s[16:19], s3 offen offset:3072 sc1
    v_cvt_pk_bf16_f32 v100, v4, v5
    v_cvt_pk_bf16_f32 v101, v6, v7
    v_cvt_pk_bf16_f32 v102, v12, v13
    v_cvt_pk_bf16_f32 v103, v14, v15
    s_mov_b32 s3, 4096
    v_permlane16_swap_b32 v100, v102
    v_permlane16_swap_b32 v101, v103
    buffer_store_dwordx4 v[100:103], v141, s[16:19], s3 offen offset:0 sc1
    v_cvt_pk_bf16_f32 v104, v20, v21
    v_cvt_pk_bf16_f32 v105, v22, v23
    v_cvt_pk_bf16_f32 v106, v28, v29
    v_cvt_pk_bf16_f32 v107, v30, v31
    s_nop 0
    v_permlane16_swap_b32 v104, v106
    v_permlane16_swap_b32 v105, v107
    buffer_store_dwordx4 v[104:107], v141, s[16:19], s3 offen offset:1024 sc1
    v_cvt_pk_bf16_f32 v108, v36, v37
    v_cvt_pk_bf16_f32 v109, v38, v39
    v_cvt_pk_bf16_f32 v110, v44, v45
    v_cvt_pk_bf16_f32 v111, v46, v47
    s_nop 0
    v_permlane16_swap_b32 v108, v110
    v_permlane16_swap_b32 v109, v111
    buffer_store_dwordx4 v[108:111], v141, s[16:19], s3 offen offset:2048 sc1
    v_cvt_pk_bf16_f32 v112, v52, v53
    v_cvt_pk_bf16_f32 v113, v54, v55
    v_cvt_pk_bf16_f32 v114, v60, v61
    v_cvt_pk_bf16_f32 v115, v62, v63
    s_nop 0
    v_permlane16_swap_b32 v112, v114
    v_permlane16_swap_b32 v113, v115
    buffer_store_dwordx4 v[112:115], v141, s[16:19], s3 offen offset:3072 sc1
    v_cvt_pk_bf16_f32 v116, v64, v65
    v_cvt_pk_bf16_f32 v117, v66, v67
    v_cvt_pk_bf16_f32 v118, v68, v69
    v_cvt_pk_bf16_f32 v119, v70, v71
    s_mov_b32 s3, 8192
    v_permlane16_swap_b32 v116, v118
    v_permlane16_swap_b32 v117, v119
    buffer_store_dwordx4 v[116:119], v141, s[16:19], s3 offen offset:0 sc1
    s_waitcnt lgkmcnt(3)
    v_cvt_pk_bf16_f32 v180, v72, v73
    v_cvt_pk_bf16_f32 v181, v74, v75
    s_waitcnt lgkmcnt(2)
    v_cvt_pk_bf16_f32 v182, v76, v77
    v_cvt_pk_bf16_f32 v183, v78, v79
    s_nop 0
    v_permlane16_swap_b32 v180, v182
    v_permlane16_swap_b32 v181, v183
    buffer_store_dwordx4 v[180:183], v141, s[16:19], s3 offen offset:1024 sc1
    s_waitcnt lgkmcnt(1)
    v_cvt_pk_bf16_f32 v184, v80, v81
    v_cvt_pk_bf16_f32 v185, v82, v83
    s_waitcnt lgkmcnt(0)
    v_cvt_pk_bf16_f32 v186, v80, v81
    v_cvt_pk_bf16_f32 v187, v82, v83
    s_nop 0
    v_permlane16_swap_b32 v184, v186
    v_permlane16_swap_b32 v185, v187
    buffer_store_dwordx4 v[184:187], v141, s[16:19], s3 offen offset:2048 sc1
    s_branch P2_RED
P2_OWN:
    v_cvt_pk_bf16_f32 v84, v0, v1
    v_cvt_pk_bf16_f32 v85, v2, v3
    v_cvt_pk_bf16_f32 v86, v8, v9
    v_cvt_pk_bf16_f32 v87, v10, v11
    s_mov_b32 s3, 0
    v_permlane16_swap_b32 v84, v86
    v_permlane16_swap_b32 v85, v87
    ds_write_b128 v141, v[84:87] offset:0
    v_cvt_pk_bf16_f32 v88, v16, v17
    v_cvt_pk_bf16_f32 v89, v18, v19
    v_cvt_pk_bf16_f32 v90, v24, v25
    v_cvt_pk_bf16_f32 v91, v26, v27
    s_nop 0
    v_permlane16_swap_b32 v88, v90
    v_permlane16_swap_b32 v89, v91
    ds_write_b128 v141, v[88:91] offset:1024
    v_cvt_pk_bf16_f32 v92, v32, v33
    v_cvt_pk_bf16_f32 v93, v34, v35
    v_cvt_pk_bf16_f32 v94, v40, v41
    v_cvt_pk_bf16_f32 v95, v42, v43
    s_nop 0
    v_permlane16_swap_b32 v92, v94
    v_permlane16_swap_b32 v93, v95
    ds_write_b128 v141, v[92:95] offset:2048
    v_cvt_pk_bf16_f32 v96, v48, v49
    v_cvt_pk_bf16_f32 v97, v50, v51
    v_cvt_pk_bf16_f32 v98, v56, v57
    v_cvt_pk_bf16_f32 v99, v58, v59
    s_nop 0
    v_permlane16_swap_b32 v96, v98
    v_permlane16_swap_b32 v97, v99
    ds_write_b128 v141, v[96:99] offset:3072
    v_cvt_pk_bf16_f32 v100, v4, v5
    v_cvt_pk_bf16_f32 v101, v6, v7
    v_cvt_pk_bf16_f32 v102, v12, v13
    v_cvt_pk_bf16_f32 v103, v14, v15
    s_mov_b32 s3, 4096
    v_permlane16_swap_b32 v100, v102
    v_permlane16_swap_b32 v101, v103
    ds_write_b128 v141, v[100:103] offset:4096
    v_cvt_pk_bf16_f32 v104, v20, v21
    v_cvt_pk_bf16_f32 v105, v22, v23
    v_cvt_pk_bf16_f32 v106, v28, v29
    v_cvt_pk_bf16_f32 v107, v30, v31
    s_nop 0
    v_permlane16_swap_b32 v104, v106
    v_permlane16_swap_b32 v105, v107
    ds_write_b128 v141, v[104:107] offset:5120
    v_cvt_pk_bf16_f32 v108, v36, v37
    v_cvt_pk_bf16_f32 v109, v38, v39
    v_cvt_pk_bf16_f32 v110, v44, v45
    v_cvt_pk_bf16_f32 v111, v46, v47
    s_nop 0
    v_permlane16_swap_b32 v108, v110
    v_permlane16_swap_b32 v109, v111
    ds_write_b128 v141, v[108:111] offset:6144
    v_cvt_pk_bf16_f32 v112, v52, v53
    v_cvt_pk_bf16_f32 v113, v54, v55
    v_cvt_pk_bf16_f32 v114, v60, v61
    v_cvt_pk_bf16_f32 v115, v62, v63
    s_nop 0
    v_permlane16_swap_b32 v112, v114
    v_permlane16_swap_b32 v113, v115
    ds_write_b128 v141, v[112:115] offset:7168
    v_cvt_pk_bf16_f32 v116, v64, v65
    v_cvt_pk_bf16_f32 v117, v66, v67
    v_cvt_pk_bf16_f32 v118, v68, v69
    v_cvt_pk_bf16_f32 v119, v70, v71
    s_mov_b32 s3, 8192
    v_permlane16_swap_b32 v116, v118
    v_permlane16_swap_b32 v117, v119
    ds_write_b128 v141, v[116:119] offset:8192
    s_waitcnt lgkmcnt(12)
    v_cvt_pk_bf16_f32 v180, v72, v73
    v_cvt_pk_bf16_f32 v181, v74, v75
    s_waitcnt lgkmcnt(11)
    v_cvt_pk_bf16_f32 v182, v76, v77
    v_cvt_pk_bf16_f32 v183, v78, v79
    s_nop 0
    v_permlane16_swap_b32 v180, v182
    v_permlane16_swap_b32 v181, v183
    ds_write_b128 v141, v[180:183] offset:9216
    s_waitcnt lgkmcnt(11)
    v_cvt_pk_bf16_f32 v184, v80, v81
    v_cvt_pk_bf16_f32 v185, v82, v83
    s_waitcnt lgkmcnt(10)
    v_cvt_pk_bf16_f32 v186, v80, v81
    v_cvt_pk_bf16_f32 v187, v82, v83
    s_nop 0
    v_permlane16_swap_b32 v184, v186
    v_permlane16_swap_b32 v185, v187
    ds_write_b128 v141, v[184:187] offset:10240
P2_RED:
    s_lshl_b32 s48, s58, 7
    s_add_u32 s48, s48, 8192
    s_lshl_b32 s7, s51, 2
    s_add_u32 s7, s7, s48
    s_lshl_b32 s6, s58, 4
    s_add_u32 s6, s6, s51
    s_mul_i32 s6, s6, 11264
    s_add_u32 s6, s6, 20971520
    s_add_u32 s16, s66, s6
    s_addc_u32 s17, s67, 0
    s_mov_b32 s18, 146432
    s_mov_b32 s19, 0x20000
    s_mul_i32 s6, s27, 331776
    s_mul_i32 s3, s29, 1152
    s_add_u32 s6, s6, s3
    s_mul_i32 s3, s56, 288
    s_add_u32 s6, s6, s3
    s_add_u32 s12, s68, s6
    s_addc_u32 s13, s69, 0
    s_sub_u32 s14, 2654208, s6
    s_mov_b32 s15, 0x20000
    v_mov_b32 v143, s34
    s_mov_b64 s[38:39], 15
    v_and_b32 v4, 15, v140
    v_mul_u32_u24 v4, 2304, v4
    v_lshrrev_b32 v5, 5, v140
    v_lshl_add_u32 v4, v5, 4, v4
    v_bfe_u32 v5, v140, 4, 1
    v_lshl_add_u32 v6, v5, 5, v4
    s_lshl_b32 s40, s51, 1
    s_lshr_b32 s3, s24, 2
    s_add_u32 s40, s40, s3
    s_mul_i32 s40, s40, 36864
    s_and_b32 s3, s24, 3
    s_lshl_b32 s3, s3, 6
    s_add_u32 s40, s40, s3
    s_lshl_b32 s41, s24, 10
    s_mul_i32 s42, s51, 73728
    s_add_u32 s42, s42, 256
    s_lshl_b32 s3, s51, 6
    s_add_u32 s3, s3, 294912
    s_cmp_eq_u32 s24, 1
    s_cselect_b32 s42, s3, s42
    s_cselect_b32 s45, 32, 0
    s_cmp_eq_u32 s24, 2
    s_cselect_b32 s42, 295168, s42
    s_cmp_eq_u32 s24, 0
    s_cselect_b32 s45, 36864, s45
    v_mul_lo_u32 v7, s45, v5
    v_add_u32 v7, v7, v4
    s_cmp_lg_u32 s51, 0
    s_cselect_b32 s45, 2, 3
    s_waitcnt vmcnt(0)
    s_waitcnt lgkmcnt(0)
    s_barrier
    s_cmp_eq_u32 s24, 7
    s_cbranch_scc0 P2_NG
    s_mov_b64 exec, 1
    buffer_store_dword v143, v142, s[52:55], s7 offen sc1
    s_mov_b64 exec, -1
P2_NG:
    s_lshl_b32 s3, s24, 10
    v_add_u32 v8, s3, v141
    ds_read_b128 v[32:35], v8
    ds_read_b128 v[48:51], v8 offset:8192
    s_cmp_lg_u32 s24, 0
    s_cbranch_scc1 P2_PW
    s_mov_b32 s44, 200000
P2_PR:
    s_mov_b64 exec, 15
    buffer_load_dword v143, v142, s[52:55], s48 offen sc1
    s_mov_b64 exec, -1
    s_sub_u32 s44, s44, 1
    s_cbranch_scc1 P2_PRX
    s_waitcnt vmcnt(0)
    v_cmp_eq_u32 vcc, s34, v143
    s_and_b64 s[6:7], vcc, s[38:39]
    s_cmp_eq_u64 s[6:7], s[38:39]
    s_cbranch_scc0 P2_PR
P2_PRX:
P2_PW:
    s_waitcnt lgkmcnt(0)
    s_barrier
    s_mov_b32 s46, 0xffff0000
    s_add_u32 s3, s51, 1
    s_and_b32 s3, s3, 3
    s_mul_i32 s3, s3, 45056
    s_add_u32 s3, s3, s41
    buffer_load_dwordx4 v[36:39], v141, s[16:19], s3 offen sc1
    s_add_u32 s3, s51, 2
    s_and_b32 s3, s3, 3
    s_mul_i32 s3, s3, 45056
    s_add_u32 s3, s3, s41
    buffer_load_dwordx4 v[40:43], v141, s[16:19], s3 offen sc1
    s_add_u32 s3, s51, 3
    s_and_b32 s3, s3, 3
    s_mul_i32 s3, s3, 45056
    s_add_u32 s3, s3, s41
    buffer_load_dwordx4 v[44:47], v141, s[16:19], s3 offen sc1
    s_cmp_lt_u32 s24, s45
    s_cbranch_scc1 P2_R2
    v_lshlrev_b32 v16, 16, v32
    v_and_b32 v17, s46, v32
    v_lshlrev_b32 v18, 16, v33
    v_and_b32 v19, s46, v33
    v_lshlrev_b32 v20, 16, v34
    v_and_b32 v21, s46, v34
    v_lshlrev_b32 v22, 16, v35
    v_and_b32 v23, s46, v35
    s_waitcnt vmcnt(2)
    v_lshlrev_b32 v24, 16, v36
    v_and_b32 v25, s46, v36
    v_lshlrev_b32 v26, 16, v37
    v_and_b32 v27, s46, v37
    v_lshlrev_b32 v28, 16, v38
    v_and_b32 v29, s46, v38
    v_lshlrev_b32 v30, 16, v39
    v_and_b32 v31, s46, v39
    v_add_f32 v16, v16, v24
    v_add_f32 v17, v17, v25
    v_add_f32 v18, v18, v26
    v_add_f32 v19, v19, v27
    v_add_f32 v20, v20, v28
    v_add_f32 v21, v21, v29
    v_add_f32 v22, v22, v30
    v_add_f32 v23, v23, v31
    s_waitcnt vmcnt(1)
    v_lshlrev_b32 v24, 16, v40
    v_and_b32 v25, s46, v40
    v_lshlrev_b32 v26, 16, v41
    v_and_b32 v27, s46, v41
    v_lshlrev_b32 v28, 16, v42
    v_and_b32 v29, s46, v42
    v_lshlrev_b32 v30, 16, v43
    v_and_b32 v31, s46, v43
    v_add_f32 v16, v16, v24
    v_add_f32 v17, v17, v25
    v_add_f32 v18, v18, v26
    v_add_f32 v19, v19, v27
    v_add_f32 v20, v20, v28
    v_add_f32 v21, v21, v29
    v_add_f32 v22, v22, v30
    v_add_f32 v23, v23, v31
    s_waitcnt vmcnt(0)
    v_lshlrev_b32 v24, 16, v44
    v_and_b32 v25, s46, v44
    v_lshlrev_b32 v26, 16, v45
    v_and_b32 v27, s46, v45
    v_lshlrev_b32 v28, 16, v46
    v_and_b32 v29, s46, v46
    v_lshlrev_b32 v30, 16, v47
    v_and_b32 v31, s46, v47
    v_add_f32 v16, v16, v24
    v_add_f32 v17, v17, v25
    v_add_f32 v18, v18, v26
    v_add_f32 v19, v19, v27
    v_add_f32 v20, v20, v28
    v_add_f32 v21, v21, v29
    v_add_f32 v22, v22, v30
    v_add_f32 v23, v23, v31
    v_cvt_pk_bf16_f32 v32, v16, v17
    v_cvt_pk_bf16_f32 v33, v18, v19
    v_cvt_pk_bf16_f32 v34, v20, v21
    v_cvt_pk_bf16_f32 v35, v22, v23
    buffer_store_dwordx4 v[32:35], v6, s[12:15], s40 offen
    s_branch P2_RE
P2_R2:
    s_add_u32 s41, s41, 8192
    s_add_u32 s3, s51, 1
    s_and_b32 s3, s3, 3
    s_mul_i32 s3, s3, 45056
    s_add_u32 s3, s3, s41
    buffer_load_dwordx4 v[52:55], v141, s[16:19], s3 offen sc1
    s_add_u32 s3, s51, 2
    s_and_b32 s3, s3, 3
    s_mul_i32 s3, s3, 45056
    s_add_u32 s3, s3, s41
    buffer_load_dwordx4 v[56:59], v141, s[16:19], s3 offen sc1
    s_add_u32 s3, s51, 3
    s_and_b32 s3, s3, 3
    s_mul_i32 s3, s3, 45056
    s_add_u32 s3, s3, s41
    buffer_load_dwordx4 v[60:63], v141, s[16:19], s3 offen sc1
    v_lshlrev_b32 v16, 16, v32
    v_and_b32 v17, s46, v32
    v_lshlrev_b32 v18, 16, v33
    v_and_b32 v19, s46, v33
    v_lshlrev_b32 v20, 16, v34
    v_and_b32 v21, s46, v34
    v_lshlrev_b32 v22, 16, v35
    v_and_b32 v23, s46, v35
    s_waitcnt vmcnt(5)
    v_lshlrev_b32 v24, 16, v36
    v_and_b32 v25, s46, v36
    v_lshlrev_b32 v26, 16, v37
    v_and_b32 v27, s46, v37
    v_lshlrev_b32 v28, 16, v38
    v_and_b32 v29, s46, v38
    v_lshlrev_b32 v30, 16, v39
    v_and_b32 v31, s46, v39
    v_add_f32 v16, v16, v24
    v_add_f32 v17, v17, v25
    v_add_f32 v18, v18, v26
    v_add_f32 v19, v19, v27
    v_add_f32 v20, v20, v28
    v_add_f32 v21, v21, v29
    v_add_f32 v22, v22, v30
    v_add_f32 v23, v23, v31
    s_waitcnt vmcnt(4)
    v_lshlrev_b32 v24, 16, v40
    v_and_b32 v25, s46, v40
    v_lshlrev_b32 v26, 16, v41
    v_and_b32 v27, s46, v41
    v_lshlrev_b32 v28, 16, v42
    v_and_b32 v29, s46, v42
    v_lshlrev_b32 v30, 16, v43
    v_and_b32 v31, s46, v43
    v_add_f32 v16, v16, v24
    v_add_f32 v17, v17, v25
    v_add_f32 v18, v18, v26
    v_add_f32 v19, v19, v27
    v_add_f32 v20, v20, v28
    v_add_f32 v21, v21, v29
    v_add_f32 v22, v22, v30
    v_add_f32 v23, v23, v31
    s_waitcnt vmcnt(3)
    v_lshlrev_b32 v24, 16, v44
    v_and_b32 v25, s46, v44
    v_lshlrev_b32 v26, 16, v45
    v_and_b32 v27, s46, v45
    v_lshlrev_b32 v28, 16, v46
    v_and_b32 v29, s46, v46
    v_lshlrev_b32 v30, 16, v47
    v_and_b32 v31, s46, v47
    v_add_f32 v16, v16, v24
    v_add_f32 v17, v17, v25
    v_add_f32 v18, v18, v26
    v_add_f32 v19, v19, v27
    v_add_f32 v20, v20, v28
    v_add_f32 v21, v21, v29
    v_add_f32 v22, v22, v30
    v_add_f32 v23, v23, v31
    v_cvt_pk_bf16_f32 v32, v16, v17
    v_cvt_pk_bf16_f32 v33, v18, v19
    v_cvt_pk_bf16_f32 v34, v20, v21
    v_cvt_pk_bf16_f32 v35, v22, v23
    buffer_store_dwordx4 v[32:35], v6, s[12:15], s40 offen
    v_lshlrev_b32 v16, 16, v48
    v_and_b32 v17, s46, v48
    v_lshlrev_b32 v18, 16, v49
    v_and_b32 v19, s46, v49
    v_lshlrev_b32 v20, 16, v50
    v_and_b32 v21, s46, v50
    v_lshlrev_b32 v22, 16, v51
    v_and_b32 v23, s46, v51
    s_waitcnt vmcnt(3)
    v_lshlrev_b32 v24, 16, v52
    v_and_b32 v25, s46, v52
    v_lshlrev_b32 v26, 16, v53
    v_and_b32 v27, s46, v53
    v_lshlrev_b32 v28, 16, v54
    v_and_b32 v29, s46, v54
    v_lshlrev_b32 v30, 16, v55
    v_and_b32 v31, s46, v55
    v_add_f32 v16, v16, v24
    v_add_f32 v17, v17, v25
    v_add_f32 v18, v18, v26
    v_add_f32 v19, v19, v27
    v_add_f32 v20, v20, v28
    v_add_f32 v21, v21, v29
    v_add_f32 v22, v22, v30
    v_add_f32 v23, v23, v31
    s_waitcnt vmcnt(2)
    v_lshlrev_b32 v24, 16, v56
    v_and_b32 v25, s46, v56
    v_lshlrev_b32 v26, 16, v57
    v_and_b32 v27, s46, v57
    v_lshlrev_b32 v28, 16, v58
    v_and_b32 v29, s46, v58
    v_lshlrev_b32 v30, 16, v59
    v_and_b32 v31, s46, v59
    v_add_f32 v16, v16, v24
    v_add_f32 v17, v17, v25
    v_add_f32 v18, v18, v26
    v_add_f32 v19, v19, v27
    v_add_f32 v20, v20, v28
    v_add_f32 v21, v21, v29
    v_add_f32 v22, v22, v30
    v_add_f32 v23, v23, v31
    s_waitcnt vmcnt(1)
    v_lshlrev_b32 v24, 16, v60
    v_and_b32 v25, s46, v60
    v_lshlrev_b32 v26, 16, v61
    v_and_b32 v27, s46, v61
    v_lshlrev_b32 v28, 16, v62
    v_and_b32 v29, s46, v62
    v_lshlrev_b32 v30, 16, v63
    v_and_b32 v31, s46, v63
    v_add_f32 v16, v16, v24
    v_add_f32 v17, v17, v25
    v_add_f32 v18, v18, v26
    v_add_f32 v19, v19, v27
    v_add_f32 v20, v20, v28
    v_add_f32 v21, v21, v29
    v_add_f32 v22, v22, v30
    v_add_f32 v23, v23, v31
    v_cvt_pk_bf16_f32 v48, v16, v17
    v_cvt_pk_bf16_f32 v49, v18, v19
    v_cvt_pk_bf16_f32 v50, v20, v21
    v_cvt_pk_bf16_f32 v51, v22, v23
    buffer_store_dwordx4 v[48:51], v7, s[12:15], s42 offen
P2_RE:
K1_END:
    s_endpgm
.section .rodata,"a"
.p2align 6
.amdhsa_kernel concat_heads__mha_block_cached__gqa_block_cached__near_ridge_kernel
  .amdhsa_next_free_vgpr 256
  .amdhsa_next_free_sgpr 102
  .amdhsa_accum_offset 256
  .amdhsa_group_segment_fixed_size 0
  .amdhsa_kernarg_size 104
  .amdhsa_user_sgpr_count 2
  .amdhsa_user_sgpr_kernarg_segment_ptr 1
  .amdhsa_system_sgpr_workgroup_id_x 1
  .amdhsa_float_denorm_mode_32 3
.end_amdhsa_kernel
```
